```python
import torch

def _softmax(x, axis=-1):
    return torch.softmax(x, dim=axis)
def _gelu(x):
    return torch.nn.functional.gelu(x, approximate="tanh")
def _silu(x):
    return torch.nn.functional.silu(x)
def _sigmoid(x):
    return torch.sigmoid(x)
def _layernorm(x, axis=-1, eps=1e-5):
    m = x.mean(dim=axis, keepdim=True)
    v = x.var(dim=axis, keepdim=True, unbiased=False)
    return (x - m) / torch.sqrt(v + eps)
def _scatter_add(tgt, idx, src, axis=0):
    return tgt.clone().index_add_(axis, idx, src)
def _segment_sum(src, seg, n):
    out = torch.zeros((n,) + src.shape[1:], dtype=src.dtype)
    return out.index_add_(0, seg, src)
def _pad(x, pw):
    flat = tuple(v for pair in reversed(pw) for v in pair)
    return torch.nn.functional.pad(x, flat)

kernel_name = 'sequential_preLN__sliding_block_cached__moe_arch_mod__decode'

def setup_inputs():

    _w = (lambda a: (lambda t: t.to(torch.bfloat16) if t.is_floating_point() else t)(torch.as_tensor(a)))
    def _A_setup():
        B, Sq, D = 1, 1, 576
        Hq, Hkv, Sk, Dh = 32, 16, 65536, 128
        assert Hq % Hkv == 0, (Hq, Hkv)
        return {
            "x": _w((lambda *s: torch.randn(*s, dtype=torch.bfloat16) * 0.05)(B, Sq, D)),
            "k_cache": _w((lambda *s: torch.randn(*s, dtype=torch.bfloat16) * 3.2)(B, Hkv, Sk, Dh)),
            "v_cache": _w((lambda *s: torch.randn(*s, dtype=torch.bfloat16) * 0.4)(B, Hkv, Sk, Dh)),
            "wq": _w((lambda *s: torch.randn(*s, dtype=torch.bfloat16) * 3.2)(D, Hq * Dh) * (D ** -0.5)),
            "wo": _w((lambda *s: torch.randn(*s, dtype=torch.bfloat16) * 0.4)(Hq * Dh, D) * ((Hq * Dh) ** -0.5)),
        }
    _A_in = _A_setup()

    def _B_setup():
        B, S, D, F, C = 1, 1, 576, 4608, 1
        return {
            "x": _w((lambda *s: torch.randn(*s, dtype=torch.bfloat16) * 0.05)(B, S, D)),
            "w_r": _w((lambda *s: torch.randn(*s, dtype=torch.bfloat16) * 0.05)(D)),
            "w_gate": _w((lambda *s: torch.randn(*s, dtype=torch.bfloat16) * 0.05)(D, F)),
            "w_up": _w((lambda *s: torch.randn(*s, dtype=torch.bfloat16) * 0.05)(D, F)),
            "w_down": _w((lambda *s: torch.randn(*s, dtype=torch.bfloat16) * 0.05)(F, D)),
        }
    _B_in = _B_setup()

    return {
        "A_x": _A_in["x"],
        "A_k_cache": _A_in["k_cache"],
        "A_v_cache": _A_in["v_cache"],
        "A_wq": _A_in["wq"],
        "A_wo": _A_in["wo"],
        "B_x": _B_in["x"],
        "B_w_r": _B_in["w_r"],
        "B_w_gate": _B_in["w_gate"],
        "B_w_up": _B_in["w_up"],
        "B_w_down": _B_in["w_down"],
    }

def reference(A_x, A_k_cache, A_v_cache, A_wq, A_wo, B_x, B_w_r, B_w_gate, B_w_up, B_w_down):
    def _A_ref(x, k_cache, v_cache, wq, wo):
        B, Sq, D = x.shape
        Hq, Dh = 32, 128
        Hkv, Sk = k_cache.shape[1], k_cache.shape[2]
        W = min(4096, max(256, Sk // 4))
        rep = Hq // Hkv
        q = (lambda x, *d: x.permute(*d))((x @ wq).reshape(B, Sq, Hq, Dh), 0, 2, 1, 3)
        k = (lambda x, n, axis: torch.repeat_interleave(x, n, dim=axis))(k_cache[:, :, Sk - W:, :], rep, axis=1)
        v = (lambda x, n, axis: torch.repeat_interleave(x, n, dim=axis))(v_cache[:, :, Sk - W:, :], rep, axis=1)
        scores = torch.einsum("bhqd,bhkd->bhqk", q, k) * (Dh ** -0.5)
        p = _softmax(scores, axis=-1)
        o = torch.einsum("bhqk,bhkd->bhqd", p, v)
        return (lambda x, *d: x.permute(*d))(o, 0, 2, 1, 3).reshape(B, Sq, Hq * Dh) @ wo

    def _B_ref(x, w_r, w_gate, w_up, w_down):
        B, S, D = x.shape
        C = 1
        r = x @ w_r
        idx = torch.argsort(-r, axis=-1)[:, :C]
        idx_e = (lambda x, n, axis: torch.repeat_interleave(x, n, dim=axis))(idx.reshape(B, C, 1), D, axis=2)
        x_sel = (lambda x, i, axis: torch.take_along_dim(x, i, dim=axis))(x, idx_e, axis=1)
        g = _silu(x_sel @ w_gate)
        u = x_sel @ w_up
        y = (g * u) @ w_down
        r_sel = _sigmoid((lambda x, i, axis: torch.take_along_dim(x, i, dim=axis))(r, idx, axis=1))
        y = y * r_sel.reshape(B, C, 1)
        b_off = (torch.arange(B) * S).reshape(B, 1)
        flat_idx = (idx + b_off).reshape(B * C)
        zero = (x * 0.0).reshape(B * S, D)
        upd = _scatter_add(zero, flat_idx, y.reshape(B * C, D), axis=0)
        return x + upd.reshape(B, S, D)

    x = A_x
    h = x + _A_ref(_layernorm(x, axis=-1), A_k_cache, A_v_cache, A_wq, A_wo)
    h2 = h + _B_ref(_layernorm(h, axis=-1), B_w_r, B_w_gate, B_w_up, B_w_down)
    return h2
```

```asm
; @launch grid=(256,1,1) block=(1024,1,1) lds=21504
.amdgcn_target "amdgcn-amd-amdhsa--gfx950"
.text
.globl sequential_preLN__sliding_block_cached__moe_arch_mod__decode_kernel
.p2align 10
.p2align 8
.type sequential_preLN__sliding_block_cached__moe_arch_mod__decode_kernel,@function
sequential_preLN__sliding_block_cached__moe_arch_mod__decode_kernel:
    s_cmp_ge_u32 s2, 256
    s_cbranch_scc1 L_end
    s_load_dwordx16 s[4:19], s[0:1], 0
    s_load_dwordx8 s[20:27], s[0:1], 64
    s_load_dwordx2 s[28:29], s[0:1], 96
    v_lshrrev_b32 v2, 6, v0
    v_and_b32 v1, 63, v0
    v_readfirstlane_b32 s3, v2
    v_lshlrev_b32 v4, 2, v1
    v_mov_b32 v5, 0
    s_mov_b32 exec_hi, 0
    ds_write_b32 v4, v5 offset:2816
    s_mov_b64 exec, -1
    v_and_b32 v2, 15, v1
    v_lshrrev_b32 v3, 4, v1
    s_and_b32 s30, s2, 7
    s_lshr_b32 s31, s2, 3
    s_lshr_b32 s51, s2, 7
    s_lshl_b32 s51, s51, 3
    s_add_u32 s49, s30, s51
    s_and_b32 s50, s31, 15
    s_mov_b32 s60, 262144
    s_mov_b32 s58, 0x00ff00ff
    s_mov_b32 s59, 0x00ff00ff
    s_mul_i32 s57, s30, 9
    s_add_u32 s57, s57, s31
    s_sub_u32 s63, s3, 8
    s_cmp_ge_u32 s3, 9
    s_cbranch_scc1 L_W_role
    v_bfe_u32 v121, v1, 3, 1
    v_lshl_add_u32 v121, v121, 2, v3
    v_and_b32 v122, 7, v1
    v_lshlrev_b32 v122, 4, v122
    v_lshl_add_u32 v122, v121, 13, v122
    v_add_u32 v125, 0x10000, v122
    s_lshr_b32 s51, s50, 2
    s_lshl_b32 s52, s51, 17
    s_lshl_b32 s53, s49, 9
    s_add_u32 s52, s52, s53
    s_and_b32 s53, s50, 3
    s_lshl_b32 s54, s53, 7
    s_add_u32 s52, s52, s54
    s_mov_b32 s54, 0x80000
    s_lshl_b32 s88, s49, 24
    s_lshl_b32 s89, s50, 14
    s_add_u32 s88, s88, s89
    s_and_b32 s89, s3, 1
    s_lshl_b32 s89, s89, 13
    s_add_u32 s88, s88, s89
    s_lshr_b32 s89, s3, 1
    s_lshl_b32 s89, s89, 18
    s_add_u32 s88, s88, s89
    s_add_u32 s88, s88, 0xF00000
    v_lshrrev_b32 v96, 2, v2
    v_lshlrev_b32 v96, 8, v96
    v_lshl_add_u32 v96, v3, 6, v96
    v_and_b32 v98, 3, v1
    v_lshl_add_u32 v96, v98, 4, v96
    v_lshlrev_b32 v97, 4, v1
    s_waitcnt lgkmcnt(0)
    s_load_dword s48, s[28:29], 0
    s_mov_b32 s32, s28
    s_mov_b32 s33, s29
    s_mov_b32 s34, 0x158000
    s_mov_b32 s35, 0x20000
    s_cmp_lt_u32 s3, 8
    s_cbranch_scc1 L_KV
    s_mov_b32 s44, s4
    s_mov_b32 s45, s5
    s_mov_b32 s46, 0x480
    s_mov_b32 s47, 0x20000
    s_mov_b32 s36, s10
    s_mov_b32 s37, s11
    s_mov_b32 s38, 0x480000
    s_mov_b32 s39, 0x20000
    v_lshlrev_b32 v120, 1, v1
    v_mov_b32 v123, 0
    buffer_load_ushort v8, v120, s[44:47], 0 offen offset:0
    buffer_load_ushort v9, v120, s[44:47], 0 offen offset:128
    buffer_load_ushort v10, v120, s[44:47], 0 offen offset:256
    buffer_load_ushort v11, v120, s[44:47], 0 offen offset:384
    buffer_load_ushort v12, v120, s[44:47], 0 offen offset:512
    buffer_load_ushort v13, v120, s[44:47], 0 offen offset:640
    buffer_load_ushort v14, v120, s[44:47], 0 offen offset:768
    buffer_load_ushort v15, v120, s[44:47], 0 offen offset:896
    buffer_load_ushort v16, v120, s[44:47], 0 offen offset:1024
    buffer_load_ushort v17, v123, s[44:47], 0 offen
    buffer_load_dwordx4 v[32:35], v122, s[36:39], s52 offen nt
    buffer_load_dwordx4 v[36:39], v125, s[36:39], s52 offen nt
    s_add_u32 s52, s52, s54
    buffer_load_dwordx4 v[40:43], v122, s[36:39], s52 offen nt
    buffer_load_dwordx4 v[44:47], v125, s[36:39], s52 offen nt
    s_add_u32 s52, s52, s54
    buffer_load_dwordx4 v[48:51], v122, s[36:39], s52 offen nt
    buffer_load_dwordx4 v[52:55], v125, s[36:39], s52 offen nt
    s_add_u32 s52, s52, s54
    buffer_load_dwordx4 v[56:59], v122, s[36:39], s52 offen nt
    buffer_load_dwordx4 v[60:63], v125, s[36:39], s52 offen nt
    s_add_u32 s52, s52, s54
    buffer_load_dwordx4 v[64:67], v122, s[36:39], s52 offen nt
    buffer_load_dwordx4 v[68:71], v125, s[36:39], s52 offen nt
    s_add_u32 s52, s52, s54
    buffer_load_dwordx4 v[72:75], v122, s[36:39], s52 offen nt
    buffer_load_dwordx4 v[76:79], v125, s[36:39], s52 offen nt
    s_add_u32 s52, s52, s54
    buffer_load_dwordx4 v[80:83], v122, s[36:39], s52 offen nt
    buffer_load_dwordx4 v[84:87], v125, s[36:39], s52 offen nt
    s_add_u32 s52, s52, s54
    buffer_load_dwordx4 v[88:91], v122, s[36:39], s52 offen nt
    buffer_load_dwordx4 v[92:95], v125, s[36:39], s52 offen nt
    s_add_u32 s52, s52, s54
    buffer_load_dwordx4 v[96:99], v122, s[36:39], s52 offen nt
    buffer_load_dwordx4 v[100:103], v125, s[36:39], s52 offen nt
    s_barrier
    s_branch L_Q2
L_W_role:
    s_waitcnt lgkmcnt(0)
    s_barrier
    s_load_dword s48, s[28:29], 0
    s_mov_b32 s32, s28
    s_mov_b32 s33, s29
    s_mov_b32 s34, 0x158000
    s_mov_b32 s35, 0x20000
    s_branch L_warm_done
L_KV:
    s_mov_b32 s36, s6
    s_mov_b32 s37, s7
    s_mov_b32 s38, 0x10000000
    s_mov_b32 s39, 0x20000
    s_mov_b32 s40, s8
    s_mov_b32 s41, s9
    s_mov_b32 s42, 0x10000000
    s_mov_b32 s43, 0x20000
    s_mov_b32 s51, s88
    s_add_u32 s52, s51, 4096
    s_barrier
    buffer_load_dwordx4 v[32:35], v96, s[36:39], s51 offen offset:0 nt
    buffer_load_dwordx4 v[36:39], v96, s[36:39], s51 offen offset:1024 nt
    buffer_load_dwordx4 v[40:43], v96, s[36:39], s51 offen offset:2048 nt
    buffer_load_dwordx4 v[44:47], v96, s[36:39], s51 offen offset:3072 nt
    v_and_b32 v8, 1, v1
    v_lshlrev_b32 v8, 4, v8
    v_mov_b32 v9, 0xffff
    v_lshlrev_b32 v8, v8, v9
    v_bfe_u32 v9, v1, 1, 2
    v_cmp_eq_u32 vcc, 0, v9
    s_nop 1
    v_cndmask_b32 v4, 0, v8, vcc
    v_cmp_eq_u32 vcc, 1, v9
    s_nop 1
    v_cndmask_b32 v5, 0, v8, vcc
    v_cmp_eq_u32 vcc, 2, v9
    s_nop 1
    v_cndmask_b32 v6, 0, v8, vcc
    v_cmp_eq_u32 vcc, 3, v9
    s_nop 1
    v_cndmask_b32 v7, 0, v8, vcc
    s_waitcnt lgkmcnt(0)
    s_mul_i32 s48, s48, 1664525
    s_add_u32 s48, s48, 1013904223
    v_mov_b32 v101, s48
    v_mov_b32 v103, s48
    v_mov_b32 v105, s48
    v_mov_b32 v107, s48
    v_mov_b32 v109, s48
    v_mov_b32 v111, s48
    v_lshrrev_b32 v112, 5, v1
    v_bfe_u32 v113, v1, 3, 1
    v_lshl_add_u32 v112, v112, 1, v113
    v_mul_u32_u24 v112, 10368, v112
    v_and_b32 v113, 7, v1
    v_lshl_add_u32 v114, v113, 4, v112
    v_bfe_u32 v113, v1, 4, 1
    v_lshl_add_u32 v112, v113, 7, v114
    s_mul_i32 s53, s49, 41472
    s_add_u32 s53, s53, 147456
    s_lshl_b32 s54, s50, 9
    s_add_u32 s54, s54, s53
    s_lshl_b32 s55, s50, 7
    s_add_u32 s55, s55, s53
    s_add_u32 s55, s55, 8192
    v_bfe_u32 v99, v1, 3, 1
    v_lshlrev_b32 v99, 8, v99
    v_lshl_add_u32 v99, v3, 6, v99
    v_lshl_add_u32 v98, v98, 4, v99
    v_mov_b32 v99, 0
    s_lshl_b32 s61, s3, 2
    v_mov_b32 v116, s61
    v_mov_b32 v117, 1
    v_bfe_u32 v118, v1, 3, 1
    v_lshlrev_b32 v118, 6, v118
    s_lshl_b32 s61, s3, 3
    v_add_u32 v118, s61, v118
    s_lshl_b32 s61, s3, 10
    v_add_u32 v119, s61, v97
    v_and_b32 v120, 7, v1
    v_lshlrev_b32 v120, 2, v120
    v_lshrrev_b32 v121, 5, v1
    v_lshlrev_b32 v121, 6, v121
    v_lshl_add_u32 v121, v120, 1, v121
    s_waitcnt vmcnt(3)
    buffer_load_dwordx4 v[48:51], v96, s[36:39], s52 offen offset:0 nt
    s_waitcnt vmcnt(3)
    buffer_load_dwordx4 v[52:55], v96, s[36:39], s52 offen offset:1024 nt
    s_waitcnt vmcnt(3)
    buffer_load_dwordx4 v[56:59], v96, s[36:39], s52 offen offset:2048 nt
    s_waitcnt vmcnt(3)
    buffer_load_dwordx4 v[60:63], v96, s[36:39], s52 offen offset:3072 nt
    s_waitcnt vmcnt(3)
    buffer_load_dwordx4 v[64:67], v97, s[40:43], s51 offen offset:0 nt
    s_waitcnt vmcnt(3)
    buffer_load_dwordx4 v[68:71], v97, s[40:43], s51 offen offset:1024 nt
    s_waitcnt vmcnt(3)
    buffer_load_dwordx4 v[72:75], v97, s[40:43], s51 offen offset:2048 nt
    s_waitcnt vmcnt(3)
    buffer_load_dwordx4 v[76:79], v97, s[40:43], s51 offen offset:3072 nt
    s_waitcnt vmcnt(3)
    buffer_load_dwordx4 v[80:83], v97, s[40:43], s52 offen offset:0 nt
    s_waitcnt vmcnt(3)
    buffer_load_dwordx4 v[84:87], v97, s[40:43], s52 offen offset:1024 nt
    s_waitcnt vmcnt(3)
    buffer_load_dwordx4 v[88:91], v97, s[40:43], s52 offen offset:2048 nt
    s_waitcnt vmcnt(3)
    buffer_load_dwordx4 v[92:95], v97, s[40:43], s52 offen offset:3072 nt
    ds_write_b32 v116, v117 offset:2848
L_qf_1:
    ds_read_b32 v115, v99 offset:2880
    ds_read_b128 v[16:19], v98 offset:2304
    s_waitcnt lgkmcnt(0)
    v_cmp_ne_u32 vcc, 0, v115
    s_cbranch_vccnz L_qfd_2
    s_sleep 1
    s_sub_u32 s60, s60, 1
    s_cmp_lg_u32 s60, 0
    s_cbranch_scc1 L_qf_1
    s_branch L_exit
L_qfd_2:
    v_readfirstlane_b32 s56, v115
    s_waitcnt vmcnt(8)
    v_mfma_f32_16x16x32_bf16 v[28:31], v[32:35], v[16:19], 0
    v_mfma_f32_16x16x32_bf16 v[32:35], v[36:39], v[16:19], 0
    v_mfma_f32_16x16x32_bf16 v[36:39], v[40:43], v[16:19], 0
    v_mfma_f32_16x16x32_bf16 v[40:43], v[44:47], v[16:19], 0
    v_mfma_f32_16x16x32_bf16 v[44:47], v[48:51], v[16:19], 0
    v_mfma_f32_16x16x32_bf16 v[48:51], v[52:55], v[16:19], 0
    v_mfma_f32_16x16x32_bf16 v[52:55], v[56:59], v[16:19], 0
    v_mfma_f32_16x16x32_bf16 v[56:59], v[60:63], v[16:19], 0
    v_mov_b32_dpp v8, v28 quad_perm:[0,0,0,0] row_mask:0xf bank_mask:0xf
    v_mov_b32_dpp v9, v32 quad_perm:[0,0,0,0] row_mask:0xf bank_mask:0xf
    v_mov_b32_dpp v10, v36 quad_perm:[0,0,0,0] row_mask:0xf bank_mask:0xf
    v_mov_b32_dpp v11, v40 quad_perm:[0,0,0,0] row_mask:0xf bank_mask:0xf
    v_mov_b32_dpp v12, v44 quad_perm:[0,0,0,0] row_mask:0xf bank_mask:0xf
    v_mov_b32_dpp v13, v48 quad_perm:[0,0,0,0] row_mask:0xf bank_mask:0xf
    v_mov_b32_dpp v14, v52 quad_perm:[0,0,0,0] row_mask:0xf bank_mask:0xf
    v_mov_b32_dpp v15, v56 quad_perm:[0,0,0,0] row_mask:0xf bank_mask:0xf
    v_add_f32_dpp v8, v29, v8 quad_perm:[1,1,1,1] row_mask:0xf bank_mask:0xf
    v_add_f32_dpp v9, v33, v9 quad_perm:[1,1,1,1] row_mask:0xf bank_mask:0xf
    v_add_f32_dpp v10, v37, v10 quad_perm:[1,1,1,1] row_mask:0xf bank_mask:0xf
    v_add_f32_dpp v11, v41, v11 quad_perm:[1,1,1,1] row_mask:0xf bank_mask:0xf
    v_add_f32_dpp v12, v45, v12 quad_perm:[1,1,1,1] row_mask:0xf bank_mask:0xf
    v_add_f32_dpp v13, v49, v13 quad_perm:[1,1,1,1] row_mask:0xf bank_mask:0xf
    v_add_f32_dpp v14, v53, v14 quad_perm:[1,1,1,1] row_mask:0xf bank_mask:0xf
    v_add_f32_dpp v15, v57, v15 quad_perm:[1,1,1,1] row_mask:0xf bank_mask:0xf
    v_add_f32_dpp v8, v30, v8 quad_perm:[2,2,2,2] row_mask:0xf bank_mask:0xf
    v_add_f32_dpp v9, v34, v9 quad_perm:[2,2,2,2] row_mask:0xf bank_mask:0xf
    v_add_f32_dpp v10, v38, v10 quad_perm:[2,2,2,2] row_mask:0xf bank_mask:0xf
    v_add_f32_dpp v11, v42, v11 quad_perm:[2,2,2,2] row_mask:0xf bank_mask:0xf
    v_add_f32_dpp v12, v46, v12 quad_perm:[2,2,2,2] row_mask:0xf bank_mask:0xf
    v_add_f32_dpp v13, v50, v13 quad_perm:[2,2,2,2] row_mask:0xf bank_mask:0xf
    v_add_f32_dpp v14, v54, v14 quad_perm:[2,2,2,2] row_mask:0xf bank_mask:0xf
    v_add_f32_dpp v15, v58, v15 quad_perm:[2,2,2,2] row_mask:0xf bank_mask:0xf
    v_add_f32_dpp v8, v31, v8 quad_perm:[3,3,3,3] row_mask:0xf bank_mask:0xf
    v_add_f32_dpp v9, v35, v9 quad_perm:[3,3,3,3] row_mask:0xf bank_mask:0xf
    v_add_f32_dpp v10, v39, v10 quad_perm:[3,3,3,3] row_mask:0xf bank_mask:0xf
    v_add_f32_dpp v11, v43, v11 quad_perm:[3,3,3,3] row_mask:0xf bank_mask:0xf
    v_add_f32_dpp v12, v47, v12 quad_perm:[3,3,3,3] row_mask:0xf bank_mask:0xf
    v_add_f32_dpp v13, v51, v13 quad_perm:[3,3,3,3] row_mask:0xf bank_mask:0xf
    v_add_f32_dpp v14, v55, v14 quad_perm:[3,3,3,3] row_mask:0xf bank_mask:0xf
    v_add_f32_dpp v15, v59, v15 quad_perm:[3,3,3,3] row_mask:0xf bank_mask:0xf
    v_cvt_pk_bf16_f32 v16, v8, v9
    v_cvt_pk_bf16_f32 v17, v10, v11
    v_cvt_pk_bf16_f32 v18, v12, v13
    v_cvt_pk_bf16_f32 v19, v14, v15
    v_lshlrev_b32 v8, 16, v16
    v_and_b32 v9, 0xffff0000, v16
    v_lshlrev_b32 v10, 16, v17
    v_and_b32 v11, 0xffff0000, v17
    v_lshlrev_b32 v12, 16, v18
    v_and_b32 v13, 0xffff0000, v18
    v_lshlrev_b32 v14, 16, v19
    v_and_b32 v15, 0xffff0000, v19
    v_mul_f32 v8, 0x3db504f3, v8
    v_mul_f32 v9, 0x3db504f3, v9
    v_mul_f32 v10, 0x3db504f3, v10
    v_mul_f32 v11, 0x3db504f3, v11
    v_mul_f32 v12, 0x3db504f3, v12
    v_mul_f32 v13, 0x3db504f3, v13
    v_mul_f32 v14, 0x3db504f3, v14
    v_mul_f32 v15, 0x3db504f3, v15
    v_cvt_pk_bf16_f32 v16, v8, v9
    v_cvt_pk_bf16_f32 v17, v10, v11
    v_cvt_pk_bf16_f32 v18, v12, v13
    v_cvt_pk_bf16_f32 v19, v14, v15
    v_lshlrev_b32 v8, 16, v16
    v_and_b32 v9, 0xffff0000, v16
    v_lshlrev_b32 v10, 16, v17
    v_and_b32 v11, 0xffff0000, v17
    v_lshlrev_b32 v12, 16, v18
    v_and_b32 v13, 0xffff0000, v18
    v_lshlrev_b32 v14, 16, v19
    v_and_b32 v15, 0xffff0000, v19
    v_max3_f32 v20, v8, v9, v10
    v_max3_f32 v21, v11, v12, v13
    v_max3_f32 v20, v20, v14, v15
    v_max_f32 v20, v20, v21
    v_mov_b32 v21, v20
    s_nop 1
    v_permlane16_swap_b32 v20, v21
    v_max_f32 v20, v20, v21
    v_mov_b32 v21, v20
    s_nop 1
    v_permlane32_swap_b32 v20, v21
    v_max_f32 v20, v20, v21
    s_mov_b32 s61, 0x3fb8aa3b
    v_mul_f32 v20, s61, v20
    v_fma_f32 v8, v8, s61, -v20
    v_fma_f32 v9, v9, s61, -v20
    v_fma_f32 v10, v10, s61, -v20
    v_fma_f32 v11, v11, s61, -v20
    v_fma_f32 v12, v12, s61, -v20
    v_fma_f32 v13, v13, s61, -v20
    v_fma_f32 v14, v14, s61, -v20
    v_fma_f32 v15, v15, s61, -v20
    v_exp_f32 v8, v8
    v_exp_f32 v9, v9
    v_exp_f32 v10, v10
    v_exp_f32 v11, v11
    v_exp_f32 v12, v12
    v_exp_f32 v13, v13
    v_exp_f32 v14, v14
    v_exp_f32 v15, v15
    v_cvt_pk_bf16_f32 v24, v8, v8
    v_cvt_pk_bf16_f32 v25, v9, v9
    v_cvt_pk_bf16_f32 v26, v10, v10
    v_cvt_pk_bf16_f32 v27, v11, v11
    v_cvt_pk_bf16_f32 v28, v12, v12
    v_cvt_pk_bf16_f32 v29, v13, v13
    v_cvt_pk_bf16_f32 v30, v14, v14
    v_cvt_pk_bf16_f32 v31, v15, v15
    v_add_f32 v21, v8, v9
    v_add_f32 v22, v10, v11
    v_add_f32 v23, v12, v13
    v_add_f32 v8, v14, v15
    v_add_f32 v21, v21, v22
    v_add_f32 v23, v23, v8
    v_add_f32 v21, v21, v23
    v_mov_b32 v22, v21
    s_nop 1
    v_permlane16_swap_b32 v21, v22
    v_add_f32 v21, v21, v22
    v_mov_b32 v22, v21
    s_nop 1
    v_permlane32_swap_b32 v21, v22
    v_add_f32 v21, v21, v22
    s_mov_b64 exec, 0x101
    ds_write_b64 v118, v[20:21] offset:2944
    s_mov_b64 exec, -1
    v_and_b32 v32, v24, v4
    v_and_b32 v33, v24, v5
    v_and_b32 v34, v24, v6
    v_and_b32 v35, v24, v7
    v_and_b32 v36, v25, v4
    v_and_b32 v37, v25, v5
    v_and_b32 v38, v25, v6
    v_and_b32 v39, v25, v7
    s_waitcnt vmcnt(7)
    v_mfma_f32_16x16x32_bf16 v[8:11], v[32:35], v[64:67], 0
    v_and_b32 v32, v26, v4
    v_and_b32 v33, v26, v5
    v_and_b32 v34, v26, v6
    v_and_b32 v35, v26, v7
    s_waitcnt vmcnt(6)
    v_mfma_f32_16x16x32_bf16 v[8:11], v[36:39], v[68:71], v[8:11]
    v_and_b32 v36, v27, v4
    v_and_b32 v37, v27, v5
    v_and_b32 v38, v27, v6
    v_and_b32 v39, v27, v7
    s_waitcnt vmcnt(5)
    v_mfma_f32_16x16x32_bf16 v[8:11], v[32:35], v[72:75], v[8:11]
    v_and_b32 v32, v28, v4
    v_and_b32 v33, v28, v5
    v_and_b32 v34, v28, v6
    v_and_b32 v35, v28, v7
    s_waitcnt vmcnt(4)
    v_mfma_f32_16x16x32_bf16 v[8:11], v[36:39], v[76:79], v[8:11]
    v_and_b32 v36, v29, v4
    v_and_b32 v37, v29, v5
    v_and_b32 v38, v29, v6
    v_and_b32 v39, v29, v7
    s_waitcnt vmcnt(3)
    v_mfma_f32_16x16x32_bf16 v[8:11], v[32:35], v[80:83], v[8:11]
    v_and_b32 v32, v30, v4
    v_and_b32 v33, v30, v5
    v_and_b32 v34, v30, v6
    v_and_b32 v35, v30, v7
    s_waitcnt vmcnt(2)
    v_mfma_f32_16x16x32_bf16 v[8:11], v[36:39], v[84:87], v[8:11]
    v_and_b32 v36, v31, v4
    v_and_b32 v37, v31, v5
    v_and_b32 v38, v31, v6
    v_and_b32 v39, v31, v7
    s_waitcnt vmcnt(1)
    v_mfma_f32_16x16x32_bf16 v[8:11], v[32:35], v[88:91], v[8:11]
    s_waitcnt vmcnt(0)
    v_mfma_f32_16x16x32_bf16 v[8:11], v[36:39], v[92:95], v[8:11]
    s_nop 7
    ds_write_b128 v119, v[8:11] offset:3072
    ds_write_b32 v116, v117 offset:2816
    ds_read_b32 v14, v120 offset:2816
    s_waitcnt lgkmcnt(0)
    v_cmp_eq_u32 vcc, 0, v14
    s_cbranch_vccnz L_kv_after
    ds_read_b64 v[16:17], v121 offset:2944
    ds_read_b128 v[32:35], v97 offset:3072
    ds_read_b128 v[36:39], v97 offset:4096
    ds_read_b128 v[40:43], v97 offset:5120
    ds_read_b128 v[44:47], v97 offset:6144
    ds_read_b128 v[48:51], v97 offset:7168
    ds_read_b128 v[52:55], v97 offset:8192
    ds_read_b128 v[56:59], v97 offset:9216
    ds_read_b128 v[60:63], v97 offset:10240
    s_waitcnt lgkmcnt(8)
    v_max_f32_dpp v108, v16, v16 row_ror:4 row_mask:0xf bank_mask:0xf
    s_nop 1
    v_max_f32_dpp v108, v108, v108 row_ror:2 row_mask:0xf bank_mask:0xf
    s_nop 1
    v_max_f32_dpp v108, v108, v108 row_ror:1 row_mask:0xf bank_mask:0xf
    v_sub_f32 v16, v16, v108
    v_exp_f32 v16, v16
    s_nop 0
    v_mul_f32 v110, v16, v17
    s_waitcnt lgkmcnt(0)
    v_mul_f32_dpp v100, v16, v32 row_newbcast:0 row_mask:0xf bank_mask:0xf
    v_mul_f32_dpp v102, v16, v33 row_newbcast:0 row_mask:0xf bank_mask:0xf
    v_mul_f32_dpp v104, v16, v34 row_newbcast:0 row_mask:0xf bank_mask:0xf
    v_mul_f32_dpp v106, v16, v35 row_newbcast:0 row_mask:0xf bank_mask:0xf
    v_add_f32_dpp v110, v110, v110 row_ror:4 row_mask:0xf bank_mask:0xf
    v_fmac_f32_dpp v100, v16, v36 row_newbcast:1 row_mask:0xf bank_mask:0xf
    v_fmac_f32_dpp v102, v16, v37 row_newbcast:1 row_mask:0xf bank_mask:0xf
    v_fmac_f32_dpp v104, v16, v38 row_newbcast:1 row_mask:0xf bank_mask:0xf
    v_fmac_f32_dpp v106, v16, v39 row_newbcast:1 row_mask:0xf bank_mask:0xf
    v_add_f32_dpp v110, v110, v110 row_ror:2 row_mask:0xf bank_mask:0xf
    v_fmac_f32_dpp v100, v16, v40 row_newbcast:2 row_mask:0xf bank_mask:0xf
    v_fmac_f32_dpp v102, v16, v41 row_newbcast:2 row_mask:0xf bank_mask:0xf
    v_fmac_f32_dpp v104, v16, v42 row_newbcast:2 row_mask:0xf bank_mask:0xf
    v_fmac_f32_dpp v106, v16, v43 row_newbcast:2 row_mask:0xf bank_mask:0xf
    v_add_f32_dpp v110, v110, v110 row_ror:1 row_mask:0xf bank_mask:0xf
    v_fmac_f32_dpp v100, v16, v44 row_newbcast:3 row_mask:0xf bank_mask:0xf
    v_fmac_f32_dpp v102, v16, v45 row_newbcast:3 row_mask:0xf bank_mask:0xf
    v_fmac_f32_dpp v104, v16, v46 row_newbcast:3 row_mask:0xf bank_mask:0xf
    v_fmac_f32_dpp v106, v16, v47 row_newbcast:3 row_mask:0xf bank_mask:0xf
    v_fmac_f32_dpp v100, v16, v48 row_newbcast:4 row_mask:0xf bank_mask:0xf
    v_fmac_f32_dpp v102, v16, v49 row_newbcast:4 row_mask:0xf bank_mask:0xf
    v_fmac_f32_dpp v104, v16, v50 row_newbcast:4 row_mask:0xf bank_mask:0xf
    v_fmac_f32_dpp v106, v16, v51 row_newbcast:4 row_mask:0xf bank_mask:0xf
    v_fmac_f32_dpp v100, v16, v52 row_newbcast:5 row_mask:0xf bank_mask:0xf
    v_fmac_f32_dpp v102, v16, v53 row_newbcast:5 row_mask:0xf bank_mask:0xf
    v_fmac_f32_dpp v104, v16, v54 row_newbcast:5 row_mask:0xf bank_mask:0xf
    v_fmac_f32_dpp v106, v16, v55 row_newbcast:5 row_mask:0xf bank_mask:0xf
    v_fmac_f32_dpp v100, v16, v56 row_newbcast:6 row_mask:0xf bank_mask:0xf
    v_fmac_f32_dpp v102, v16, v57 row_newbcast:6 row_mask:0xf bank_mask:0xf
    v_fmac_f32_dpp v104, v16, v58 row_newbcast:6 row_mask:0xf bank_mask:0xf
    v_fmac_f32_dpp v106, v16, v59 row_newbcast:6 row_mask:0xf bank_mask:0xf
    v_fmac_f32_dpp v100, v16, v60 row_newbcast:7 row_mask:0xf bank_mask:0xf
    v_fmac_f32_dpp v102, v16, v61 row_newbcast:7 row_mask:0xf bank_mask:0xf
    v_fmac_f32_dpp v104, v16, v62 row_newbcast:7 row_mask:0xf bank_mask:0xf
    v_fmac_f32_dpp v106, v16, v63 row_newbcast:7 row_mask:0xf bank_mask:0xf
    s_cmp_eq_u32 s56, 2
    s_cbranch_scc1 L_pub_local
    buffer_store_dwordx4 v[100:103], v112, s[32:35], s54 offen sc1
    buffer_store_dwordx4 v[104:107], v112, s[32:35], s54 offen offset:256 sc1
    s_mov_b32 exec_lo, 0xffff
    s_mov_b32 exec_hi, 0xffff
    buffer_store_dwordx4 v[108:111], v114, s[32:35], s55 offen sc1
    s_branch L_pub_done
L_pub_local:
    buffer_store_dwordx4 v[100:103], v112, s[32:35], s54 offen
    buffer_store_dwordx4 v[104:107], v112, s[32:35], s54 offen offset:256
    s_mov_b32 exec_lo, 0xffff
    s_mov_b32 exec_hi, 0xffff
    buffer_store_dwordx4 v[108:111], v114, s[32:35], s55 offen
L_pub_done:
    s_mov_b64 exec, -1
    ds_write_b32 v99, v117 offset:2884
L_kv_after:
    s_cmp_lt_u32 s31, 9
    s_cbranch_scc1 L_kv_F
    s_cmp_ge_u32 s31, 17
    s_cbranch_scc1 L_exit
    s_cmp_lg_u32 s3, 0
    s_cbranch_scc1 L_exit
    s_setprio 3
    s_sub_u32 s63, s31, 9
    s_lshr_b32 s62, s63, 2
    s_lshl_b32 s62, s62, 5
    s_and_b32 s61, s63, 3
    s_add_u32 s61, s61, s62
    s_lshl_b32 s62, s30, 2
    s_add_u32 s51, s61, s62
    s_mul_i32 s88, s51, 10368
    s_add_u32 s88, s88, 147456
    s_add_u32 s89, s88, 4096
    s_add_u32 s90, s88, 8192
    v_lshrrev_b32 v12, 5, v1
    v_xor_b32 v125, v12, v2
    v_lshlrev_b32 v125, 7, v125
    s_lshl_b32 s55, s30, 12
    s_lshl_b32 s61, s63, 9
    s_add_u32 s55, s55, s61
    s_add_u32 s55, s55, 1376256
    v_lshlrev_b32 v124, 3, v1
    v_and_b32 v10, 0, v1
    v_lshlrev_b32 v10, 2, v10
L_fl_3:
    ds_read_b32 v11, v10 offset:2884
    s_waitcnt lgkmcnt(0)
    v_cmp_eq_u32 vcc, 0, v11
    s_cbranch_vccz L_fld_4
    s_sleep 1
    s_sub_u32 s60, s60, 1
    s_cmp_lg_u32 s60, 0
    s_cbranch_scc1 L_fl_3
    s_branch L_exit
L_fld_4:
    buffer_load_dwordx4 v[28:31], v125, s[32:35], s90 offen sc1
    buffer_load_dwordx4 v[64:67], v97, s[32:35], s88 offen offset:0 sc1
    buffer_load_dwordx4 v[68:71], v97, s[32:35], s88 offen offset:1024 sc1
    buffer_load_dwordx4 v[72:75], v97, s[32:35], s88 offen offset:2048 sc1
    buffer_load_dwordx4 v[76:79], v97, s[32:35], s88 offen offset:3072 sc1
    buffer_load_dwordx4 v[80:83], v97, s[32:35], s89 offen offset:0 sc1
    buffer_load_dwordx4 v[84:87], v97, s[32:35], s89 offen offset:1024 sc1
    buffer_load_dwordx4 v[88:91], v97, s[32:35], s89 offen offset:2048 sc1
    buffer_load_dwordx4 v[92:95], v97, s[32:35], s89 offen offset:3072 sc1
L_g_5:
    s_waitcnt vmcnt(0)
    v_xor_b32 v32, s48, v29
    v_bitop3_b32 v32, v32, v31, s48 bitop3:0xf6
    v_xor_b32 v33, s48, v65
    v_bitop3_b32 v33, v33, v67, s48 bitop3:0xf6
    v_xor_b32 v34, s48, v69
    v_bitop3_b32 v34, v34, v71, s48 bitop3:0xf6
    v_xor_b32 v35, s48, v73
    v_bitop3_b32 v35, v35, v75, s48 bitop3:0xf6
    v_xor_b32 v36, s48, v77
    v_bitop3_b32 v36, v36, v79, s48 bitop3:0xf6
    v_xor_b32 v37, s48, v81
    v_bitop3_b32 v37, v37, v83, s48 bitop3:0xf6
    v_xor_b32 v38, s48, v85
    v_bitop3_b32 v38, v38, v87, s48 bitop3:0xf6
    v_xor_b32 v39, s48, v89
    v_bitop3_b32 v39, v39, v91, s48 bitop3:0xf6
    v_xor_b32 v40, s48, v93
    v_bitop3_b32 v40, v40, v95, s48 bitop3:0xf6
    v_or3_b32 v41, v32, v33, v34
    v_or3_b32 v41, v41, v35, v36
    v_or3_b32 v41, v41, v37, v38
    v_or3_b32 v41, v41, v39, v40
    v_cmp_ne_u32 vcc, 0, v41
    s_cbranch_vccz L_gd_6
    v_cmp_ne_u32 vcc, 0, v32
    s_cbranch_vccz L_sk_7
    buffer_load_dwordx4 v[28:31], v125, s[32:35], s90 offen sc1
L_sk_7:
    v_cmp_ne_u32 vcc, 0, v33
    s_cbranch_vccz L_sk_8
    buffer_load_dwordx4 v[64:67], v97, s[32:35], s88 offen offset:0 sc1
L_sk_8:
    v_cmp_ne_u32 vcc, 0, v34
    s_cbranch_vccz L_sk_9
    buffer_load_dwordx4 v[68:71], v97, s[32:35], s88 offen offset:1024 sc1
L_sk_9:
    v_cmp_ne_u32 vcc, 0, v35
    s_cbranch_vccz L_sk_10
    buffer_load_dwordx4 v[72:75], v97, s[32:35], s88 offen offset:2048 sc1
L_sk_10:
    v_cmp_ne_u32 vcc, 0, v36
    s_cbranch_vccz L_sk_11
    buffer_load_dwordx4 v[76:79], v97, s[32:35], s88 offen offset:3072 sc1
L_sk_11:
    v_cmp_ne_u32 vcc, 0, v37
    s_cbranch_vccz L_sk_12
    buffer_load_dwordx4 v[80:83], v97, s[32:35], s89 offen offset:0 sc1
L_sk_12:
    v_cmp_ne_u32 vcc, 0, v38
    s_cbranch_vccz L_sk_13
    buffer_load_dwordx4 v[84:87], v97, s[32:35], s89 offen offset:1024 sc1
L_sk_13:
    v_cmp_ne_u32 vcc, 0, v39
    s_cbranch_vccz L_sk_14
    buffer_load_dwordx4 v[88:91], v97, s[32:35], s89 offen offset:2048 sc1
L_sk_14:
    v_cmp_ne_u32 vcc, 0, v40
    s_cbranch_vccz L_sk_15
    buffer_load_dwordx4 v[92:95], v97, s[32:35], s89 offen offset:3072 sc1
L_sk_15:
    s_sub_u32 s60, s60, 1
    s_cmp_lg_u32 s60, 0
    s_cbranch_scc1 L_g_5
    s_branch L_exit
L_gd_6:
    ds_write_b32 v99, v117 offset:2892
    v_max_f32_dpp v16, v28, v28 row_ror:8 row_mask:0xf bank_mask:0xf
    s_nop 1
    v_max_f32_dpp v16, v16, v16 row_ror:4 row_mask:0xf bank_mask:0xf
    s_nop 1
    v_max_f32_dpp v16, v16, v16 row_ror:2 row_mask:0xf bank_mask:0xf
    s_nop 1
    v_max_f32_dpp v16, v16, v16 row_ror:1 row_mask:0xf bank_mask:0xf
    v_sub_f32 v16, v28, v16
    v_exp_f32 v16, v16
    s_nop 0
    v_mul_f32 v17, v16, v30
    v_mul_f32_dpp v18, v16, v64 row_newbcast:0 row_mask:0xf bank_mask:0xf
    v_mul_f32_dpp v19, v16, v66 row_newbcast:0 row_mask:0xf bank_mask:0xf
    v_add_f32_dpp v17, v17, v17 row_ror:8 row_mask:0xf bank_mask:0xf
    v_fmac_f32_dpp v18, v16, v68 row_newbcast:2 row_mask:0xf bank_mask:0xf
    v_fmac_f32_dpp v19, v16, v70 row_newbcast:2 row_mask:0xf bank_mask:0xf
    v_add_f32_dpp v17, v17, v17 row_ror:4 row_mask:0xf bank_mask:0xf
    v_fmac_f32_dpp v18, v16, v72 row_newbcast:4 row_mask:0xf bank_mask:0xf
    v_fmac_f32_dpp v19, v16, v74 row_newbcast:4 row_mask:0xf bank_mask:0xf
    v_add_f32_dpp v17, v17, v17 row_ror:2 row_mask:0xf bank_mask:0xf
    v_fmac_f32_dpp v18, v16, v76 row_newbcast:6 row_mask:0xf bank_mask:0xf
    v_fmac_f32_dpp v19, v16, v78 row_newbcast:6 row_mask:0xf bank_mask:0xf
    v_add_f32_dpp v17, v17, v17 row_ror:1 row_mask:0xf bank_mask:0xf
    v_fmac_f32_dpp v18, v16, v80 row_newbcast:8 row_mask:0xf bank_mask:0xf
    v_fmac_f32_dpp v19, v16, v82 row_newbcast:8 row_mask:0xf bank_mask:0xf
    s_nop 0
    v_fmac_f32_dpp v18, v16, v84 row_newbcast:10 row_mask:0xf bank_mask:0xf
    v_fmac_f32_dpp v19, v16, v86 row_newbcast:10 row_mask:0xf bank_mask:0xf
    s_nop 0
    v_fmac_f32_dpp v18, v16, v88 row_newbcast:12 row_mask:0xf bank_mask:0xf
    v_fmac_f32_dpp v19, v16, v90 row_newbcast:12 row_mask:0xf bank_mask:0xf
    s_nop 0
    v_fmac_f32_dpp v18, v16, v92 row_newbcast:14 row_mask:0xf bank_mask:0xf
    v_fmac_f32_dpp v19, v16, v94 row_newbcast:14 row_mask:0xf bank_mask:0xf
    v_rcp_f32 v17, v17
    s_nop 0
    v_permlane32_swap_b32 v18, v19
    v_add_f32 v18, v18, v19
    s_cmp_eq_u32 s56, 2
    v_mul_f32 v18, v18, v17
    v_cvt_pk_bf16_f32 v100, v18, v18
    s_cbranch_scc1 L_ho_local
    buffer_store_dwordx2 v[100:101], v124, s[32:35], s55 offen sc1
    s_branch L_exit
L_ho_local:
    buffer_store_dwordx2 v[100:101], v124, s[32:35], s55 offen
    s_branch L_exit
L_kv_F:
    s_mov_b32 s40, s22
    s_mov_b32 s41, s23
    s_mov_b32 s42, 0x510000
    s_mov_b32 s43, 0x20000
    v_bfe_u32 v122, v1, 3, 1
    v_lshl_add_u32 v122, v122, 2, v3
    v_mul_u32_u24 v123, 4608, v122
    v_and_b32 v12, 7, v1
    v_lshl_add_u32 v123, v12, 4, v123
    s_mul_i32 s52, s57, 73728
    s_lshl_b32 s53, s3, 7
    s_add_u32 s52, s52, s53
    s_add_u32 s53, s52, 36864
    v_and_b32 v10, 0, v1
    v_lshlrev_b32 v10, 2, v10
L_fl_16:
    ds_read_b32 v11, v10 offset:2884
    s_waitcnt lgkmcnt(0)
    v_cmp_eq_u32 vcc, 0, v11
    s_cbranch_vccz L_fld_17
    s_sleep 1
    s_sub_u32 s60, s60, 1
    s_cmp_lg_u32 s60, 0
    s_cbranch_scc1 L_fl_16
    s_branch L_exit
L_fld_17:
    v_mov_b32 v115, v123
    s_mov_b32 s86, s52
    s_mov_b32 s87, s53
    v_bfe_u32 v123, v1, 2, 1
    v_lshl_add_u32 v123, v123, 2, v3
    v_mul_u32_u24 v123, 4736, v123
    v_and_b32 v12, 3, v1
    v_lshl_add_u32 v123, v12, 4, v123
    s_mul_i32 s52, s3, 37888
    s_lshl_b32 s53, s57, 6
    s_add_u32 s52, s52, s53
    s_add_u32 s52, s52, 860160
    s_add_u32 s53, s52, 37888
    v_lshlrev_b32 v124, 2, v1
    s_lshl_b32 s61, s3, 8
    v_add_u32 v125, s61, v124
    v_lshl_add_u32 v126, v122, 4, s61
    s_lshl_b32 s54, s3, 12
    s_add_u32 s54, s54, 819200
    s_mov_b32 s55, 851968
    v_and_b32 v127, 31, v1
    v_lshlrev_b32 v127, 3, v127
    v_lshrrev_b32 v12, 5, v1
    v_lshl_add_u32 v127, v12, 2, v127
    v_add_u32 v121, s61, v127
    v_mov_b32 v12, 0
L_ct_18:
    ds_read_b32 v13, v12 offset:2892
    s_waitcnt lgkmcnt(0)
    v_cmp_gt_u32 vcc, 8, v13
    s_cbranch_vccz L_ctd_19
    s_sleep 1
    s_sub_u32 s60, s60, 1
    s_cmp_lg_u32 s60, 0
    s_cbranch_scc1 L_ct_18
    s_branch L_exit
L_ctd_19:
    s_cmp_eq_u32 s3, 0
    s_cbranch_scc1 L_h4_two
    buffer_load_dwordx4 v[8:11], v97, s[32:35], s54 offen offset:0 sc1
    buffer_load_dwordx4 v[12:15], v97, s[32:35], s54 offen offset:1024 sc1
    buffer_load_dwordx4 v[16:19], v97, s[32:35], s54 offen offset:2048 sc1
    buffer_load_dwordx4 v[20:23], v97, s[32:35], s54 offen offset:3072 sc1
L_g_20:
    s_waitcnt vmcnt(0)
    v_xor_b32 v24, s48, v9
    v_bitop3_b32 v24, v24, v11, s48 bitop3:0xf6
    v_xor_b32 v25, s48, v13
    v_bitop3_b32 v25, v25, v15, s48 bitop3:0xf6
    v_xor_b32 v26, s48, v17
    v_bitop3_b32 v26, v26, v19, s48 bitop3:0xf6
    v_xor_b32 v27, s48, v21
    v_bitop3_b32 v27, v27, v23, s48 bitop3:0xf6
    v_or3_b32 v28, v24, v25, v26
    v_or_b32 v28, v28, v27
    v_cmp_ne_u32 vcc, 0, v28
    s_cbranch_vccz L_gd_21
    v_cmp_ne_u32 vcc, 0, v24
    s_cbranch_vccz L_sk_22
    buffer_load_dwordx4 v[8:11], v97, s[32:35], s54 offen offset:0 sc1
L_sk_22:
    v_cmp_ne_u32 vcc, 0, v25
    s_cbranch_vccz L_sk_23
    buffer_load_dwordx4 v[12:15], v97, s[32:35], s54 offen offset:1024 sc1
L_sk_23:
    v_cmp_ne_u32 vcc, 0, v26
    s_cbranch_vccz L_sk_24
    buffer_load_dwordx4 v[16:19], v97, s[32:35], s54 offen offset:2048 sc1
L_sk_24:
    v_cmp_ne_u32 vcc, 0, v27
    s_cbranch_vccz L_sk_25
    buffer_load_dwordx4 v[20:23], v97, s[32:35], s54 offen offset:3072 sc1
L_sk_25:
    s_sub_u32 s60, s60, 1
    s_cmp_lg_u32 s60, 0
    s_cbranch_scc1 L_g_20
    s_branch L_exit
L_gd_21:
    s_branch L_h4_one
L_h4_two:
    buffer_load_dwordx4 v[8:11], v97, s[32:35], s54 offen offset:0 sc1
    buffer_load_dwordx4 v[12:15], v97, s[32:35], s54 offen offset:1024 sc1
    buffer_load_dwordx4 v[16:19], v97, s[32:35], s54 offen offset:2048 sc1
    buffer_load_dwordx4 v[20:23], v97, s[32:35], s54 offen offset:3072 sc1
    buffer_load_dwordx4 v[64:67], v97, s[32:35], s55 offen offset:0 sc1
    buffer_load_dwordx4 v[68:71], v97, s[32:35], s55 offen offset:1024 sc1
    buffer_load_dwordx4 v[72:75], v97, s[32:35], s55 offen offset:2048 sc1
    buffer_load_dwordx4 v[76:79], v97, s[32:35], s55 offen offset:3072 sc1
L_g_26:
    s_waitcnt vmcnt(0)
    v_xor_b32 v80, s48, v9
    v_bitop3_b32 v80, v80, v11, s48 bitop3:0xf6
    v_xor_b32 v81, s48, v13
    v_bitop3_b32 v81, v81, v15, s48 bitop3:0xf6
    v_xor_b32 v82, s48, v17
    v_bitop3_b32 v82, v82, v19, s48 bitop3:0xf6
    v_xor_b32 v83, s48, v21
    v_bitop3_b32 v83, v83, v23, s48 bitop3:0xf6
    v_xor_b32 v84, s48, v65
    v_bitop3_b32 v84, v84, v67, s48 bitop3:0xf6
    v_xor_b32 v85, s48, v69
    v_bitop3_b32 v85, v85, v71, s48 bitop3:0xf6
    v_xor_b32 v86, s48, v73
    v_bitop3_b32 v86, v86, v75, s48 bitop3:0xf6
    v_xor_b32 v87, s48, v77
    v_bitop3_b32 v87, v87, v79, s48 bitop3:0xf6
    v_or3_b32 v88, v80, v81, v82
    v_or3_b32 v88, v88, v83, v84
    v_or3_b32 v88, v88, v85, v86
    v_or_b32 v88, v88, v87
    v_cmp_ne_u32 vcc, 0, v88
    s_cbranch_vccz L_gd_27
    v_cmp_ne_u32 vcc, 0, v80
    s_cbranch_vccz L_sk_28
    buffer_load_dwordx4 v[8:11], v97, s[32:35], s54 offen offset:0 sc1
L_sk_28:
    v_cmp_ne_u32 vcc, 0, v81
    s_cbranch_vccz L_sk_29
    buffer_load_dwordx4 v[12:15], v97, s[32:35], s54 offen offset:1024 sc1
L_sk_29:
    v_cmp_ne_u32 vcc, 0, v82
    s_cbranch_vccz L_sk_30
    buffer_load_dwordx4 v[16:19], v97, s[32:35], s54 offen offset:2048 sc1
L_sk_30:
    v_cmp_ne_u32 vcc, 0, v83
    s_cbranch_vccz L_sk_31
    buffer_load_dwordx4 v[20:23], v97, s[32:35], s54 offen offset:3072 sc1
L_sk_31:
    v_cmp_ne_u32 vcc, 0, v84
    s_cbranch_vccz L_sk_32
    buffer_load_dwordx4 v[64:67], v97, s[32:35], s55 offen offset:0 sc1
L_sk_32:
    v_cmp_ne_u32 vcc, 0, v85
    s_cbranch_vccz L_sk_33
    buffer_load_dwordx4 v[68:71], v97, s[32:35], s55 offen offset:1024 sc1
L_sk_33:
    v_cmp_ne_u32 vcc, 0, v86
    s_cbranch_vccz L_sk_34
    buffer_load_dwordx4 v[72:75], v97, s[32:35], s55 offen offset:2048 sc1
L_sk_34:
    v_cmp_ne_u32 vcc, 0, v87
    s_cbranch_vccz L_sk_35
    buffer_load_dwordx4 v[76:79], v97, s[32:35], s55 offen offset:3072 sc1
L_sk_35:
    s_sub_u32 s60, s60, 1
    s_cmp_lg_u32 s60, 0
    s_cbranch_scc1 L_g_26
    s_branch L_exit
L_gd_27:
    v_add_f32 v64, v64, v68
    v_add_f32 v66, v66, v70
    v_add_f32 v72, v72, v76
    v_add_f32 v74, v74, v78
    v_add_f32 v64, v64, v72
    v_add_f32 v66, v66, v74
    s_nop 1
    v_permlane32_swap_b32 v64, v66
    v_add_f32 v64, v64, v66
    v_cvt_pk_bf16_f32 v64, v64, v64
    ds_write_b32 v127, v64 offset:2048
L_h4_one:
    v_add_f32 v8, v8, v12
    v_add_f32 v10, v10, v14
    v_add_f32 v16, v16, v20
    v_add_f32 v18, v18, v22
    v_add_f32 v8, v8, v16
    v_add_f32 v10, v10, v18
    s_nop 1
    v_permlane32_swap_b32 v8, v10
    v_add_f32 v8, v8, v10
    v_cvt_pk_bf16_f32 v8, v8, v8
    ds_write_b32 v121, v8 offset:0
    s_waitcnt lgkmcnt(0)
    s_barrier
    buffer_load_dwordx4 v[32:35], v115, s[40:43], s86 offen offset:0 nt
    buffer_load_dwordx4 v[36:39], v115, s[40:43], s86 offen offset:1152 nt
    buffer_load_dwordx4 v[40:43], v115, s[40:43], s86 offen offset:2304 nt
    buffer_load_dwordx4 v[44:47], v115, s[40:43], s86 offen offset:3456 nt
    s_cmp_lg_u32 s3, 7
    s_cbranch_scc1 L_dn_36
    buffer_load_dwordx4 v[64:67], v115, s[40:43], s86 offen offset:128 nt
    buffer_load_dwordx4 v[68:71], v115, s[40:43], s86 offen offset:1280 nt
    buffer_load_dwordx4 v[72:75], v115, s[40:43], s86 offen offset:2432 nt
    buffer_load_dwordx4 v[76:79], v115, s[40:43], s86 offen offset:3584 nt
L_dn_36:
    buffer_load_dwordx4 v[48:51], v115, s[40:43], s87 offen offset:0 nt
    buffer_load_dwordx4 v[52:55], v115, s[40:43], s87 offen offset:1152 nt
    buffer_load_dwordx4 v[56:59], v115, s[40:43], s87 offen offset:2304 nt
    buffer_load_dwordx4 v[60:63], v115, s[40:43], s87 offen offset:3456 nt
    s_cmp_lg_u32 s3, 7
    s_cbranch_scc1 L_dn_37
    buffer_load_dwordx4 v[80:83], v115, s[40:43], s87 offen offset:128 nt
    buffer_load_dwordx4 v[84:87], v115, s[40:43], s87 offen offset:1280 nt
    buffer_load_dwordx4 v[88:91], v115, s[40:43], s87 offen offset:2432 nt
    buffer_load_dwordx4 v[92:95], v115, s[40:43], s87 offen offset:3584 nt
L_dn_37:
    s_cmp_lg_u32 s3, 1
    s_cbranch_scc1 L_nostat
    s_setprio 3
    ds_read2st64_b32 v[8:9], v124 offset0:0 offset1:1
    ds_read2st64_b32 v[10:11], v124 offset0:2 offset1:3
    ds_read2st64_b32 v[12:13], v124 offset0:4 offset1:5
    ds_read2st64_b32 v[14:15], v124 offset0:6 offset1:7
    ds_read_b32 v16, v124 offset:2048
    ds_read_b32 v17, v99 offset:0
    s_waitcnt lgkmcnt(0)
    v_and_b32 v8, 0xffff0000, v8
    v_and_b32 v9, 0xffff0000, v9
    v_and_b32 v10, 0xffff0000, v10
    v_and_b32 v11, 0xffff0000, v11
    v_and_b32 v12, 0xffff0000, v12
    v_and_b32 v13, 0xffff0000, v13
    v_and_b32 v14, 0xffff0000, v14
    v_and_b32 v15, 0xffff0000, v15
    v_and_b32 v16, 0xffff0000, v16
    v_and_b32 v17, 0xffff0000, v17
    v_sub_f32 v21, v8, v17
    v_sub_f32 v22, v9, v17
    v_sub_f32 v23, v10, v17
    v_sub_f32 v24, v11, v17
    v_sub_f32 v25, v12, v17
    v_sub_f32 v26, v13, v17
    v_sub_f32 v27, v14, v17
    v_sub_f32 v28, v15, v17
    v_sub_f32 v29, v16, v17
    v_add_f32 v18, v21, v22
    v_mul_f32 v19, v21, v21
    v_add_f32 v20, v23, v24
    v_mul_f32 v30, v22, v22
    v_fmac_f32 v19, v23, v23
    v_fmac_f32 v30, v24, v24
    v_fmac_f32 v19, v25, v25
    v_fmac_f32 v30, v26, v26
    v_fmac_f32 v19, v27, v27
    v_fmac_f32 v30, v28, v28
    v_fmac_f32 v19, v29, v29
    v_add_f32 v18, v18, v25
    v_add_f32 v20, v20, v26
    v_add_f32 v18, v18, v27
    v_add_f32 v20, v20, v28
    v_add_f32 v18, v18, v29
    v_add_f32 v19, v19, v30
    v_add_f32 v18, v18, v20
    s_nop 1
    v_permlane32_swap_b32 v18, v19
    v_add_f32 v18, v18, v19
    s_nop 1
    v_add_f32_dpp v18, v18, v18 row_ror:8 row_mask:0xf bank_mask:0xf
    s_nop 1
    v_add_f32_dpp v18, v18, v18 row_ror:4 row_mask:0xf bank_mask:0xf
    s_nop 1
    v_add_f32_dpp v18, v18, v18 row_ror:2 row_mask:0xf bank_mask:0xf
    s_nop 1
    v_add_f32_dpp v18, v18, v18 row_ror:1 row_mask:0xf bank_mask:0xf
    v_mov_b32 v20, v18
    s_nop 1
    v_permlane16_swap_b32 v18, v20
    v_add_f32 v18, v18, v20
    v_mov_b32 v19, v18
    s_nop 1
    v_permlane32_swap_b32 v18, v19
    v_mul_f32 v18, 0x3ae38e39, v18
    v_mul_f32 v19, 0x3ae38e39, v19
    v_fma_f32 v19, -v18, v18, v19
    v_add_f32 v18, v18, v17
    v_max_f32 v19, 0, v19
    v_cvt_pk_bf16_f32 v20, v18, v19
    v_lshlrev_b32 v18, 16, v20
    v_and_b32 v19, 0xffff0000, v20
    v_add_f32 v19, 0x3727c5ac, v19
    v_cvt_pk_bf16_f32 v19, v19, v19
    v_and_b32 v19, 0xffff0000, v19
    v_sqrt_f32 v19, v19
    s_nop 0
    v_cvt_pk_bf16_f32 v19, v19, v19
    v_and_b32 v19, 0xffff0000, v19
    v_rcp_f32 v19, v19
    s_mov_b64 exec, 1
    ds_write_b64 v99, v[18:19] offset:2928
    s_mov_b64 exec, -1
L_nostat:
    ds_read2st64_b32 v[8:9], v124 offset0:68 offset1:69
    ds_read2st64_b32 v[10:11], v124 offset0:70 offset1:71
    ds_read2st64_b32 v[12:13], v124 offset0:72 offset1:73
    ds_read2st64_b32 v[14:15], v124 offset0:74 offset1:75
    ds_read2st64_b32 v[16:17], v124 offset0:76 offset1:77
    ds_read2st64_b32 v[18:19], v124 offset0:78 offset1:79
    ds_read2st64_b32 v[20:21], v124 offset0:80 offset1:81
    ds_read2st64_b32 v[22:23], v124 offset0:82 offset1:83
    s_waitcnt lgkmcnt(0)
    v_pk_add_f32 v[8:9], v[8:9], v[10:11]
    v_pk_add_f32 v[12:13], v[12:13], v[14:15]
    v_pk_add_f32 v[16:17], v[16:17], v[18:19]
    v_pk_add_f32 v[20:21], v[20:21], v[22:23]
    v_pk_add_f32 v[8:9], v[8:9], v[12:13]
    v_pk_add_f32 v[16:17], v[16:17], v[20:21]
    v_pk_add_f32 v[118:119], v[8:9], v[16:17]
    s_barrier
    ds_read_b64 v[24:25], v99 offset:2928
    ds_read2st64_b32 v[8:9], v124 offset0:44 offset1:45
    ds_read2st64_b32 v[10:11], v124 offset0:46 offset1:47
    ds_read2st64_b32 v[12:13], v124 offset0:48 offset1:49
    ds_read2st64_b32 v[14:15], v124 offset0:50 offset1:51
    ds_read2st64_b32 v[16:17], v124 offset0:52 offset1:53
    ds_read2st64_b32 v[18:19], v124 offset0:54 offset1:55
    ds_read2st64_b32 v[20:21], v124 offset0:56 offset1:57
    ds_read2st64_b32 v[22:23], v124 offset0:58 offset1:59
    s_waitcnt lgkmcnt(0)
    v_pk_add_f32 v[8:9], v[8:9], v[10:11]
    v_pk_add_f32 v[12:13], v[12:13], v[14:15]
    v_pk_add_f32 v[16:17], v[16:17], v[18:19]
    v_pk_add_f32 v[20:21], v[20:21], v[22:23]
    v_pk_add_f32 v[8:9], v[8:9], v[12:13]
    v_pk_add_f32 v[16:17], v[16:17], v[20:21]
    v_pk_add_f32 v[8:9], v[8:9], v[16:17]
    v_fma_f32 v8, -v24, v118, v8
    v_fma_f32 v9, -v24, v119, v9
    v_mul_f32 v8, v8, v25
    v_mul_f32 v9, v9, v25
    v_mul_f32 v10, 0xbfb8aa3b, v8
    v_exp_f32 v10, v10
    v_mul_f32 v9, v9, v8
    v_add_f32 v10, 1.0, v10
    v_rcp_f32 v10, v10
    s_nop 0
    v_mul_f32 v10, v10, v9
    v_cvt_pk_bf16_f32 v10, v10, v10
    ds_write_b32 v125, v10 offset:15360
    ds_read_b128 v[16:19], v126 offset:15360
    ds_read_b128 v[20:23], v126 offset:15488
    s_waitcnt vmcnt(0) lgkmcnt(0)
    s_cmp_eq_u32 s3, 7
    s_cbranch_scc1 L_dn_c
    v_and_b32 v24, v16, v4
    v_and_b32 v25, v16, v5
    v_and_b32 v26, v16, v6
    v_and_b32 v27, v16, v7
    v_and_b32 v28, v17, v4
    v_and_b32 v29, v17, v5
    v_and_b32 v30, v17, v6
    v_and_b32 v31, v17, v7
    v_mfma_f32_16x16x32_bf16 v[8:11], v[24:27], v[32:35], 0
    v_and_b32 v24, v18, v4
    v_and_b32 v25, v18, v5
    v_and_b32 v26, v18, v6
    v_and_b32 v27, v18, v7
    v_mfma_f32_16x16x32_bf16 v[8:11], v[28:31], v[36:39], v[8:11]
    v_and_b32 v28, v19, v4
    v_and_b32 v29, v19, v5
    v_and_b32 v30, v19, v6
    v_and_b32 v31, v19, v7
    v_mfma_f32_16x16x32_bf16 v[8:11], v[24:27], v[40:43], v[8:11]
    v_and_b32 v24, v20, v4
    v_and_b32 v25, v20, v5
    v_and_b32 v26, v20, v6
    v_and_b32 v27, v20, v7
    v_mfma_f32_16x16x32_bf16 v[8:11], v[28:31], v[44:47], v[8:11]
    v_and_b32 v28, v21, v4
    v_and_b32 v29, v21, v5
    v_and_b32 v30, v21, v6
    v_and_b32 v31, v21, v7
    v_mfma_f32_16x16x32_bf16 v[8:11], v[24:27], v[48:51], v[8:11]
    v_and_b32 v24, v22, v4
    v_and_b32 v25, v22, v5
    v_and_b32 v26, v22, v6
    v_and_b32 v27, v22, v7
    v_mfma_f32_16x16x32_bf16 v[8:11], v[28:31], v[52:55], v[8:11]
    v_and_b32 v28, v23, v4
    v_and_b32 v29, v23, v5
    v_and_b32 v30, v23, v6
    v_and_b32 v31, v23, v7
    v_mfma_f32_16x16x32_bf16 v[8:11], v[24:27], v[56:59], v[8:11]
    s_nop 0
    v_mfma_f32_16x16x32_bf16 v[8:11], v[28:31], v[60:63], v[8:11]
    s_nop 7
    v_permlane32_swap_b32 v8, v10
    v_permlane32_swap_b32 v9, v11
    s_nop 0
    v_add_f32_dpp v100, v10, v8 row_ror:8 row_mask:0xf bank_mask:0xf
    v_add_f32_dpp v102, v11, v9 row_ror:8 row_mask:0xf bank_mask:0xf
    s_mov_b64 exec, s[58:59]
    buffer_store_dwordx4 v[100:103], v123, s[32:35], s52 offen sc1
    s_branch L_exit
L_dn_c:
    v_and_b32 v24, v16, v4
    v_and_b32 v25, v16, v5
    v_and_b32 v26, v16, v6
    v_and_b32 v27, v16, v7
    v_and_b32 v28, v17, v4
    v_and_b32 v29, v17, v5
    v_mfma_f32_16x16x32_bf16 v[8:11], v[24:27], v[32:35], 0
    v_and_b32 v30, v17, v6
    v_and_b32 v31, v17, v7
    v_mfma_f32_16x16x32_bf16 v[12:15], v[24:27], v[64:67], 0
    v_and_b32 v24, v18, v4
    v_and_b32 v25, v18, v5
    v_mfma_f32_16x16x32_bf16 v[8:11], v[28:31], v[36:39], v[8:11]
    v_and_b32 v26, v18, v6
    v_and_b32 v27, v18, v7
    v_mfma_f32_16x16x32_bf16 v[12:15], v[28:31], v[68:71], v[12:15]
    v_and_b32 v28, v19, v4
    v_and_b32 v29, v19, v5
    v_mfma_f32_16x16x32_bf16 v[8:11], v[24:27], v[40:43], v[8:11]
    v_and_b32 v30, v19, v6
    v_and_b32 v31, v19, v7
    v_mfma_f32_16x16x32_bf16 v[12:15], v[24:27], v[72:75], v[12:15]
    v_and_b32 v24, v20, v4
    v_and_b32 v25, v20, v5
    v_mfma_f32_16x16x32_bf16 v[8:11], v[28:31], v[44:47], v[8:11]
    v_and_b32 v26, v20, v6
    v_and_b32 v27, v20, v7
    v_mfma_f32_16x16x32_bf16 v[12:15], v[28:31], v[76:79], v[12:15]
    v_and_b32 v28, v21, v4
    v_and_b32 v29, v21, v5
    v_mfma_f32_16x16x32_bf16 v[8:11], v[24:27], v[48:51], v[8:11]
    v_and_b32 v30, v21, v6
    v_and_b32 v31, v21, v7
    v_mfma_f32_16x16x32_bf16 v[12:15], v[24:27], v[80:83], v[12:15]
    v_and_b32 v24, v22, v4
    v_and_b32 v25, v22, v5
    v_mfma_f32_16x16x32_bf16 v[8:11], v[28:31], v[52:55], v[8:11]
    v_and_b32 v26, v22, v6
    v_and_b32 v27, v22, v7
    v_mfma_f32_16x16x32_bf16 v[12:15], v[28:31], v[84:87], v[12:15]
    v_and_b32 v28, v23, v4
    v_and_b32 v29, v23, v5
    v_mfma_f32_16x16x32_bf16 v[8:11], v[24:27], v[56:59], v[8:11]
    v_and_b32 v30, v23, v6
    v_and_b32 v31, v23, v7
    v_mfma_f32_16x16x32_bf16 v[12:15], v[24:27], v[88:91], v[12:15]
    s_nop 0
    v_mfma_f32_16x16x32_bf16 v[8:11], v[28:31], v[60:63], v[8:11]
    v_mfma_f32_16x16x32_bf16 v[12:15], v[28:31], v[92:95], v[12:15]
    s_nop 6
    v_permlane32_swap_b32 v8, v10
    v_permlane32_swap_b32 v9, v11
    s_nop 0
    v_add_f32_dpp v100, v10, v8 row_ror:8 row_mask:0xf bank_mask:0xf
    v_add_f32_dpp v102, v11, v9 row_ror:8 row_mask:0xf bank_mask:0xf
    v_permlane32_swap_b32 v12, v14
    v_permlane32_swap_b32 v13, v15
    s_nop 0
    v_add_f32_dpp v104, v14, v12 row_ror:8 row_mask:0xf bank_mask:0xf
    v_add_f32_dpp v106, v15, v13 row_ror:8 row_mask:0xf bank_mask:0xf
    s_mov_b64 exec, s[58:59]
    buffer_store_dwordx4 v[100:103], v123, s[32:35], s52 offen sc1
    buffer_store_dwordx4 v[104:107], v123, s[32:35], s53 offen sc1
    s_branch L_exit
L_Q2:
    s_mov_b32 s40, s16
    s_mov_b32 s41, s17
    s_mov_b32 s42, 0x480
    s_mov_b32 s43, 0x20000
    s_setprio 3
    s_getreg_b32 s56, hwreg(HW_REG_XCC_ID, 0, 4)
    v_and_b32 v28, 1, v1
    v_lshlrev_b32 v28, 4, v28
    v_mov_b32 v29, 0xffff
    v_lshlrev_b32 v28, v28, v29
    v_bfe_u32 v29, v1, 1, 2
    v_cmp_eq_u32 vcc, 0, v29
    s_nop 1
    v_cndmask_b32 v4, 0, v28, vcc
    v_cmp_eq_u32 vcc, 1, v29
    s_nop 1
    v_cndmask_b32 v5, 0, v28, vcc
    v_cmp_eq_u32 vcc, 2, v29
    s_nop 1
    v_cndmask_b32 v6, 0, v28, vcc
    v_cmp_eq_u32 vcc, 3, v29
    s_nop 1
    v_cndmask_b32 v7, 0, v28, vcc
    v_lshlrev_b32 v123, 2, v1
    s_waitcnt vmcnt(18)
    v_lshlrev_b32 v8, 16, v8
    v_lshlrev_b32 v9, 16, v9
    v_lshlrev_b32 v10, 16, v10
    v_lshlrev_b32 v11, 16, v11
    v_lshlrev_b32 v12, 16, v12
    v_lshlrev_b32 v13, 16, v13
    v_lshlrev_b32 v14, 16, v14
    v_lshlrev_b32 v15, 16, v15
    v_lshlrev_b32 v16, 16, v16
    v_lshlrev_b32 v17, 16, v17
    v_sub_f32 v107, v8, v17
    v_sub_f32 v108, v9, v17
    v_sub_f32 v109, v10, v17
    v_sub_f32 v110, v11, v17
    v_sub_f32 v111, v12, v17
    v_sub_f32 v112, v13, v17
    v_sub_f32 v113, v14, v17
    v_sub_f32 v114, v15, v17
    v_sub_f32 v115, v16, v17
    v_add_f32 v104, v107, v108
    v_mul_f32 v105, v107, v107
    v_add_f32 v106, v109, v110
    v_mul_f32 v116, v108, v108
    v_fmac_f32 v105, v109, v109
    v_fmac_f32 v116, v110, v110
    v_fmac_f32 v105, v111, v111
    v_fmac_f32 v116, v112, v112
    v_fmac_f32 v105, v113, v113
    v_fmac_f32 v116, v114, v114
    v_fmac_f32 v105, v115, v115
    v_add_f32 v104, v104, v111
    v_add_f32 v106, v106, v112
    v_add_f32 v104, v104, v113
    v_add_f32 v106, v106, v114
    v_add_f32 v104, v104, v115
    v_add_f32 v105, v105, v116
    v_add_f32 v104, v104, v106
    s_nop 1
    v_permlane32_swap_b32 v104, v105
    v_add_f32 v104, v104, v105
    s_nop 1
    v_add_f32_dpp v104, v104, v104 row_ror:8 row_mask:0xf bank_mask:0xf
    s_nop 1
    v_add_f32_dpp v104, v104, v104 row_ror:4 row_mask:0xf bank_mask:0xf
    s_nop 1
    v_add_f32_dpp v104, v104, v104 row_ror:2 row_mask:0xf bank_mask:0xf
    s_nop 1
    v_add_f32_dpp v104, v104, v104 row_ror:1 row_mask:0xf bank_mask:0xf
    v_mov_b32 v106, v104
    s_nop 1
    v_permlane16_swap_b32 v104, v106
    v_add_f32 v104, v104, v106
    v_mov_b32 v105, v104
    s_nop 1
    v_permlane32_swap_b32 v104, v105
    v_mul_f32 v104, 0x3ae38e39, v104
    v_mul_f32 v105, 0x3ae38e39, v105
    v_fma_f32 v105, -v104, v104, v105
    v_add_f32 v104, v104, v17
    v_max_f32 v105, 0, v105
    v_cvt_pk_bf16_f32 v106, v104, v105
    v_lshlrev_b32 v104, 16, v106
    v_and_b32 v105, 0xffff0000, v106
    v_add_f32 v105, 0x3727c5ac, v105
    v_cvt_pk_bf16_f32 v105, v105, v105
    v_and_b32 v105, 0xffff0000, v105
    v_sqrt_f32 v105, v105
    s_nop 0
    v_cvt_pk_bf16_f32 v105, v105, v105
    v_and_b32 v105, 0xffff0000, v105
    v_rcp_f32 v105, v105
    v_sub_f32 v8, v8, v104
    v_sub_f32 v9, v9, v104
    v_sub_f32 v10, v10, v104
    v_sub_f32 v11, v11, v104
    v_sub_f32 v12, v12, v104
    v_sub_f32 v13, v13, v104
    v_sub_f32 v14, v14, v104
    v_sub_f32 v15, v15, v104
    v_sub_f32 v16, v16, v104
    v_cvt_pk_bf16_f32 v8, v8, v8
    v_cvt_pk_bf16_f32 v9, v9, v9
    v_cvt_pk_bf16_f32 v10, v10, v10
    v_cvt_pk_bf16_f32 v11, v11, v11
    v_cvt_pk_bf16_f32 v12, v12, v12
    v_cvt_pk_bf16_f32 v13, v13, v13
    v_cvt_pk_bf16_f32 v14, v14, v14
    v_cvt_pk_bf16_f32 v15, v15, v15
    v_cvt_pk_bf16_f32 v16, v16, v16
    v_and_b32 v8, 0xffff0000, v8
    v_and_b32 v9, 0xffff0000, v9
    v_and_b32 v10, 0xffff0000, v10
    v_and_b32 v11, 0xffff0000, v11
    v_and_b32 v12, 0xffff0000, v12
    v_and_b32 v13, 0xffff0000, v13
    v_and_b32 v14, 0xffff0000, v14
    v_and_b32 v15, 0xffff0000, v15
    v_and_b32 v16, 0xffff0000, v16
    v_mul_f32 v8, v8, v105
    v_mul_f32 v9, v9, v105
    v_mul_f32 v10, v10, v105
    v_mul_f32 v11, v11, v105
    v_mul_f32 v12, v12, v105
    v_mul_f32 v13, v13, v105
    v_mul_f32 v14, v14, v105
    v_mul_f32 v15, v15, v105
    v_mul_f32 v16, v16, v105
    v_cvt_pk_bf16_f32 v8, v8, v8
    v_cvt_pk_bf16_f32 v9, v9, v9
    v_cvt_pk_bf16_f32 v10, v10, v10
    v_cvt_pk_bf16_f32 v11, v11, v11
    v_cvt_pk_bf16_f32 v12, v12, v12
    v_cvt_pk_bf16_f32 v13, v13, v13
    v_cvt_pk_bf16_f32 v14, v14, v14
    v_cvt_pk_bf16_f32 v15, v15, v15
    v_cvt_pk_bf16_f32 v16, v16, v16
    ds_write2st64_b32 v123, v8, v9 offset0:0 offset1:1
    ds_write2st64_b32 v123, v10, v11 offset0:2 offset1:3
    ds_write2st64_b32 v123, v12, v13 offset0:4 offset1:5
    ds_write2st64_b32 v123, v14, v15 offset0:6 offset1:7
    ds_write_b32 v123, v16 offset:2048
    s_lshl_b32 s54, s51, 6
    v_lshl_add_u32 v120, v121, 2, s54
    v_add_u32 v123, 32, v120
    s_waitcnt lgkmcnt(0)
    ds_read2st64_b32 v[8:9], v120 offset0:0 offset1:1
    ds_read2st64_b32 v[10:11], v120 offset0:2 offset1:3
    ds_read2st64_b32 v[12:13], v120 offset0:4 offset1:5
    ds_read2st64_b32 v[14:15], v120 offset0:6 offset1:7
    ds_read_b32 v16, v120 offset:2048
    ds_read2st64_b32 v[18:19], v123 offset0:0 offset1:1
    ds_read2st64_b32 v[20:21], v123 offset0:2 offset1:3
    ds_read2st64_b32 v[22:23], v123 offset0:4 offset1:5
    ds_read2st64_b32 v[24:25], v123 offset0:6 offset1:7
    ds_read_b32 v26, v123 offset:2048
    s_waitcnt lgkmcnt(0)
    s_mul_i32 s48, s48, 1664525
    s_add_u32 s48, s48, 1013904223
    v_and_b32 v104, v8, v4
    v_and_b32 v105, v8, v5
    v_and_b32 v106, v8, v6
    v_and_b32 v107, v8, v7
    v_and_b32 v108, v18, v4
    v_and_b32 v109, v18, v5
    v_and_b32 v110, v18, v6
    v_and_b32 v111, v18, v7
    s_waitcnt vmcnt(17)
    v_mfma_f32_16x16x32_bf16 v[112:115], v[104:107], v[32:35], 0
    v_and_b32 v104, v9, v4
    v_and_b32 v105, v9, v5
    v_and_b32 v106, v9, v6
    v_and_b32 v107, v9, v7
    s_waitcnt vmcnt(16)
    v_mfma_f32_16x16x32_bf16 v[112:115], v[108:111], v[36:39], v[112:115]
    v_and_b32 v108, v19, v4
    v_and_b32 v109, v19, v5
    v_and_b32 v110, v19, v6
    v_and_b32 v111, v19, v7
    s_waitcnt vmcnt(15)
    v_mfma_f32_16x16x32_bf16 v[112:115], v[104:107], v[40:43], v[112:115]
    v_and_b32 v104, v10, v4
    v_and_b32 v105, v10, v5
    v_and_b32 v106, v10, v6
    v_and_b32 v107, v10, v7
    s_waitcnt vmcnt(14)
    v_mfma_f32_16x16x32_bf16 v[112:115], v[108:111], v[44:47], v[112:115]
    v_and_b32 v108, v20, v4
    v_and_b32 v109, v20, v5
    v_and_b32 v110, v20, v6
    v_and_b32 v111, v20, v7
    s_waitcnt vmcnt(13)
    v_mfma_f32_16x16x32_bf16 v[112:115], v[104:107], v[48:51], v[112:115]
    v_and_b32 v104, v11, v4
    v_and_b32 v105, v11, v5
    v_and_b32 v106, v11, v6
    v_and_b32 v107, v11, v7
    s_waitcnt vmcnt(12)
    v_mfma_f32_16x16x32_bf16 v[112:115], v[108:111], v[52:55], v[112:115]
    v_and_b32 v108, v21, v4
    v_and_b32 v109, v21, v5
    v_and_b32 v110, v21, v6
    v_and_b32 v111, v21, v7
    s_waitcnt vmcnt(11)
    v_mfma_f32_16x16x32_bf16 v[112:115], v[104:107], v[56:59], v[112:115]
    v_and_b32 v104, v12, v4
    v_and_b32 v105, v12, v5
    v_and_b32 v106, v12, v6
    v_and_b32 v107, v12, v7
    s_waitcnt vmcnt(10)
    v_mfma_f32_16x16x32_bf16 v[112:115], v[108:111], v[60:63], v[112:115]
    v_and_b32 v108, v22, v4
    v_and_b32 v109, v22, v5
    v_and_b32 v110, v22, v6
    v_and_b32 v111, v22, v7
    s_waitcnt vmcnt(9)
    v_mfma_f32_16x16x32_bf16 v[112:115], v[104:107], v[64:67], v[112:115]
    v_and_b32 v104, v13, v4
    v_and_b32 v105, v13, v5
    v_and_b32 v106, v13, v6
    v_and_b32 v107, v13, v7
    s_waitcnt vmcnt(8)
    v_mfma_f32_16x16x32_bf16 v[112:115], v[108:111], v[68:71], v[112:115]
    v_and_b32 v108, v23, v4
    v_and_b32 v109, v23, v5
    v_and_b32 v110, v23, v6
    v_and_b32 v111, v23, v7
    s_waitcnt vmcnt(7)
    v_mfma_f32_16x16x32_bf16 v[112:115], v[104:107], v[72:75], v[112:115]
    v_and_b32 v104, v14, v4
    v_and_b32 v105, v14, v5
    v_and_b32 v106, v14, v6
    v_and_b32 v107, v14, v7
    s_waitcnt vmcnt(6)
    v_mfma_f32_16x16x32_bf16 v[112:115], v[108:111], v[76:79], v[112:115]
    v_and_b32 v108, v24, v4
    v_and_b32 v109, v24, v5
    v_and_b32 v110, v24, v6
    v_and_b32 v111, v24, v7
    s_waitcnt vmcnt(5)
    v_mfma_f32_16x16x32_bf16 v[112:115], v[104:107], v[80:83], v[112:115]
    v_and_b32 v104, v15, v4
    v_and_b32 v105, v15, v5
    v_and_b32 v106, v15, v6
    v_and_b32 v107, v15, v7
    s_waitcnt vmcnt(4)
    v_mfma_f32_16x16x32_bf16 v[112:115], v[108:111], v[84:87], v[112:115]
    v_and_b32 v108, v25, v4
    v_and_b32 v109, v25, v5
    v_and_b32 v110, v25, v6
    v_and_b32 v111, v25, v7
    s_waitcnt vmcnt(3)
    v_mfma_f32_16x16x32_bf16 v[112:115], v[104:107], v[88:91], v[112:115]
    v_and_b32 v104, v16, v4
    v_and_b32 v105, v16, v5
    v_and_b32 v106, v16, v6
    v_and_b32 v107, v16, v7
    s_waitcnt vmcnt(2)
    v_mfma_f32_16x16x32_bf16 v[112:115], v[108:111], v[92:95], v[112:115]
    v_and_b32 v108, v26, v4
    v_and_b32 v109, v26, v5
    v_and_b32 v110, v26, v6
    v_and_b32 v111, v26, v7
    s_waitcnt vmcnt(1)
    v_mfma_f32_16x16x32_bf16 v[112:115], v[104:107], v[96:99], v[112:115]
    s_waitcnt vmcnt(0)
    v_mfma_f32_16x16x32_bf16 v[112:115], v[108:111], v[100:103], v[112:115]
    s_add_u32 s84, s56, 1
    s_xor_b32 s84, s84, s48
    v_mov_b32 v117, s84
    v_mov_b32 v119, s84
    v_and_b32 v124, 7, v1
    v_lshl_add_u32 v124, v3, 3, v124
    v_lshlrev_b32 v124, 4, v124
    s_mul_i32 s52, s49, 8320
    s_add_u32 s52, s52, 12288
    s_lshl_b32 s88, s51, 11
    s_add_u32 s88, s88, s52
    s_lshl_b32 s55, s53, 9
    s_add_u32 s88, s88, s55
    v_permlane32_swap_b32 v112, v114
    v_permlane32_swap_b32 v113, v115
    s_nop 0
    v_add_f32_dpp v116, v114, v112 row_ror:8 row_mask:0xf bank_mask:0xf
    v_add_f32_dpp v118, v115, v113 row_ror:8 row_mask:0xf bank_mask:0xf
    s_mov_b64 exec, s[58:59]
    buffer_store_dwordx4 v[116:119], v124, s[32:35], s88 offen
    s_mov_b64 exec, -1
    v_lshlrev_b32 v120, 4, v1
    s_mul_i32 s54, s30, 1280
    s_add_u32 s54, s54, 1024
    s_sub_u32 s61, s31, 9
    s_cmp_ge_u32 s61, 9
    s_cbranch_scc1 L_noann
    s_lshl_b32 s61, s61, 7
    s_add_u32 s62, s54, s61
    s_mov_b64 exec, 0xff
    buffer_store_dwordx4 v[116:119], v120, s[32:35], s62 offen
    s_mov_b64 exec, -1
L_noann:
    s_add_u32 s53, s52, 4096
    v_min_u32 v122, 8, v1
    v_lshlrev_b32 v122, 7, v122
    s_waitcnt vmcnt(0)
    s_mov_b32 s85, 24
L_h1_local:
    buffer_load_dwordx4 v[32:35], v120, s[32:35], s52 offen offset:0 sc1
    buffer_load_dwordx4 v[36:39], v120, s[32:35], s52 offen offset:1024 sc1
    buffer_load_dwordx4 v[40:43], v120, s[32:35], s52 offen offset:2048 sc1
    buffer_load_dwordx4 v[44:47], v120, s[32:35], s52 offen offset:3072 sc1
    buffer_load_dwordx4 v[48:51], v120, s[32:35], s53 offen offset:0 sc1
    buffer_load_dwordx4 v[52:55], v120, s[32:35], s53 offen offset:1024 sc1
    buffer_load_dwordx4 v[56:59], v120, s[32:35], s53 offen offset:2048 sc1
    buffer_load_dwordx4 v[60:63], v120, s[32:35], s53 offen offset:3072 sc1
    buffer_load_dwordx2 v[64:65], v122, s[32:35], s54 offen sc1
L_g_38:
    s_waitcnt vmcnt(0)
    v_xor_b32 v68, s84, v33
    v_bitop3_b32 v68, v68, v35, s84 bitop3:0xf6
    v_xor_b32 v69, s84, v37
    v_bitop3_b32 v69, v69, v39, s84 bitop3:0xf6
    v_xor_b32 v70, s84, v41
    v_bitop3_b32 v70, v70, v43, s84 bitop3:0xf6
    v_xor_b32 v71, s84, v45
    v_bitop3_b32 v71, v71, v47, s84 bitop3:0xf6
    v_xor_b32 v72, s84, v49
    v_bitop3_b32 v72, v72, v51, s84 bitop3:0xf6
    v_xor_b32 v73, s84, v53
    v_bitop3_b32 v73, v73, v55, s84 bitop3:0xf6
    v_xor_b32 v74, s84, v57
    v_bitop3_b32 v74, v74, v59, s84 bitop3:0xf6
    v_xor_b32 v75, s84, v61
    v_bitop3_b32 v75, v75, v63, s84 bitop3:0xf6
    v_xor_b32 v76, s84, v65
    v_or3_b32 v77, v68, v69, v70
    v_or3_b32 v77, v77, v71, v72
    v_or3_b32 v77, v77, v73, v74
    v_or3_b32 v77, v77, v75, v76
    v_cmp_ne_u32 vcc, 0, v77
    s_cbranch_vccz L_gd_39
    s_sub_u32 s85, s85, 1
    s_cmp_eq_u32 s85, 0
    s_cbranch_scc1 L_h1_fb
    s_sleep 1
    v_cmp_ne_u32 vcc, 0, v68
    s_cbranch_vccz L_sk_40
    buffer_load_dwordx4 v[32:35], v120, s[32:35], s52 offen offset:0 sc1
L_sk_40:
    v_cmp_ne_u32 vcc, 0, v69
    s_cbranch_vccz L_sk_41
    buffer_load_dwordx4 v[36:39], v120, s[32:35], s52 offen offset:1024 sc1
L_sk_41:
    v_cmp_ne_u32 vcc, 0, v70
    s_cbranch_vccz L_sk_42
    buffer_load_dwordx4 v[40:43], v120, s[32:35], s52 offen offset:2048 sc1
L_sk_42:
    v_cmp_ne_u32 vcc, 0, v71
    s_cbranch_vccz L_sk_43
    buffer_load_dwordx4 v[44:47], v120, s[32:35], s52 offen offset:3072 sc1
L_sk_43:
    v_cmp_ne_u32 vcc, 0, v72
    s_cbranch_vccz L_sk_44
    buffer_load_dwordx4 v[48:51], v120, s[32:35], s53 offen offset:0 sc1
L_sk_44:
    v_cmp_ne_u32 vcc, 0, v73
    s_cbranch_vccz L_sk_45
    buffer_load_dwordx4 v[52:55], v120, s[32:35], s53 offen offset:1024 sc1
L_sk_45:
    v_cmp_ne_u32 vcc, 0, v74
    s_cbranch_vccz L_sk_46
    buffer_load_dwordx4 v[56:59], v120, s[32:35], s53 offen offset:2048 sc1
L_sk_46:
    v_cmp_ne_u32 vcc, 0, v75
    s_cbranch_vccz L_sk_47
    buffer_load_dwordx4 v[60:63], v120, s[32:35], s53 offen offset:3072 sc1
L_sk_47:
    v_cmp_ne_u32 vcc, 0, v76
    s_cbranch_vccz L_sk_48
    buffer_load_dwordx2 v[64:65], v122, s[32:35], s54 offen sc1
L_sk_48:
    s_sub_u32 s60, s60, 1
    s_cmp_lg_u32 s60, 0
    s_cbranch_scc1 L_g_38
    s_branch L_exit
L_gd_39:
    s_mov_b32 s61, 2
    s_branch L_h1_done
L_h1_fb:
    v_mov_b32 v80, v116
    v_mov_b32 v81, s48
    v_mov_b32 v82, v118
    v_mov_b32 v83, s48
    s_add_u32 s62, s88, 1212416
    s_add_u32 s89, s52, 1212416
    s_add_u32 s90, s53, 1212416
    s_mov_b64 exec, s[58:59]
    buffer_store_dwordx4 v[80:83], v124, s[32:35], s62 offen sc1
    s_mov_b64 exec, -1
    s_mov_b32 s85, 4
    buffer_load_dwordx4 v[32:35], v120, s[32:35], s89 offen offset:0 sc1
    buffer_load_dwordx4 v[36:39], v120, s[32:35], s89 offen offset:1024 sc1
    buffer_load_dwordx4 v[40:43], v120, s[32:35], s89 offen offset:2048 sc1
    buffer_load_dwordx4 v[44:47], v120, s[32:35], s89 offen offset:3072 sc1
    buffer_load_dwordx4 v[48:51], v120, s[32:35], s90 offen offset:0 sc1
    buffer_load_dwordx4 v[52:55], v120, s[32:35], s90 offen offset:1024 sc1
    buffer_load_dwordx4 v[56:59], v120, s[32:35], s90 offen offset:2048 sc1
    buffer_load_dwordx4 v[60:63], v120, s[32:35], s90 offen offset:3072 sc1
L_g_49:
    s_waitcnt vmcnt(0)
    v_xor_b32 v68, s48, v33
    v_bitop3_b32 v68, v68, v35, s48 bitop3:0xf6
    v_xor_b32 v69, s48, v37
    v_bitop3_b32 v69, v69, v39, s48 bitop3:0xf6
    v_xor_b32 v70, s48, v41
    v_bitop3_b32 v70, v70, v43, s48 bitop3:0xf6
    v_xor_b32 v71, s48, v45
    v_bitop3_b32 v71, v71, v47, s48 bitop3:0xf6
    v_xor_b32 v72, s48, v49
    v_bitop3_b32 v72, v72, v51, s48 bitop3:0xf6
    v_xor_b32 v73, s48, v53
    v_bitop3_b32 v73, v73, v55, s48 bitop3:0xf6
    v_xor_b32 v74, s48, v57
    v_bitop3_b32 v74, v74, v59, s48 bitop3:0xf6
    v_xor_b32 v75, s48, v61
    v_bitop3_b32 v75, v75, v63, s48 bitop3:0xf6
    v_or3_b32 v77, v68, v69, v70
    v_or3_b32 v77, v77, v71, v72
    v_or3_b32 v77, v77, v73, v74
    v_or_b32 v77, v77, v75
    v_cmp_ne_u32 vcc, 0, v77
    s_cbranch_vccz L_gd_50
    s_sub_u32 s85, s85, 1
    s_cmp_eq_u32 s85, 0
    s_cbranch_scc1 L_h1_again
    s_sleep 4
    v_cmp_ne_u32 vcc, 0, v68
    s_cbranch_vccz L_sk_51
    buffer_load_dwordx4 v[32:35], v120, s[32:35], s89 offen offset:0 sc1
L_sk_51:
    v_cmp_ne_u32 vcc, 0, v69
    s_cbranch_vccz L_sk_52
    buffer_load_dwordx4 v[36:39], v120, s[32:35], s89 offen offset:1024 sc1
L_sk_52:
    v_cmp_ne_u32 vcc, 0, v70
    s_cbranch_vccz L_sk_53
    buffer_load_dwordx4 v[40:43], v120, s[32:35], s89 offen offset:2048 sc1
L_sk_53:
    v_cmp_ne_u32 vcc, 0, v71
    s_cbranch_vccz L_sk_54
    buffer_load_dwordx4 v[44:47], v120, s[32:35], s89 offen offset:3072 sc1
L_sk_54:
    v_cmp_ne_u32 vcc, 0, v72
    s_cbranch_vccz L_sk_55
    buffer_load_dwordx4 v[48:51], v120, s[32:35], s90 offen offset:0 sc1
L_sk_55:
    v_cmp_ne_u32 vcc, 0, v73
    s_cbranch_vccz L_sk_56
    buffer_load_dwordx4 v[52:55], v120, s[32:35], s90 offen offset:1024 sc1
L_sk_56:
    v_cmp_ne_u32 vcc, 0, v74
    s_cbranch_vccz L_sk_57
    buffer_load_dwordx4 v[56:59], v120, s[32:35], s90 offen offset:2048 sc1
L_sk_57:
    v_cmp_ne_u32 vcc, 0, v75
    s_cbranch_vccz L_sk_58
    buffer_load_dwordx4 v[60:63], v120, s[32:35], s90 offen offset:3072 sc1
L_sk_58:
    s_sub_u32 s60, s60, 1
    s_cmp_lg_u32 s60, 0
    s_cbranch_scc1 L_g_49
    s_branch L_exit
L_gd_50:
    s_mov_b32 s61, 1
    s_branch L_h1_done
L_h1_again:
    s_mov_b32 s85, 2
    s_branch L_h1_local
L_h1_done:
    v_add_f32 v32, v32, v40
    v_add_f32 v48, v48, v56
    v_add_f32 v32, v32, v48
    v_add_f32 v34, v34, v42
    v_add_f32 v50, v50, v58
    v_add_f32 v34, v34, v50
    v_add_f32 v36, v36, v44
    v_add_f32 v52, v52, v60
    v_add_f32 v36, v36, v52
    v_add_f32 v38, v38, v46
    v_add_f32 v54, v54, v62
    v_add_f32 v38, v38, v54
    v_cvt_pk_bf16_f32 v8, v32, v34
    v_cvt_pk_bf16_f32 v9, v36, v38
    v_lshrrev_b32 v120, 5, v1
    v_lshlrev_b32 v120, 7, v120
    v_and_b32 v122, 7, v1
    v_lshl_add_u32 v120, v122, 4, v120
    v_bfe_u32 v122, v1, 3, 1
    v_lshl_add_u32 v120, v122, 3, v120
    v_bfe_u32 v122, v1, 4, 1
    v_lshl_add_u32 v120, v122, 2, v120
    ds_write_b32 v120, v8 offset:2304
    ds_write_b32 v120, v9 offset:2560
    v_mov_b32 v121, 0
    v_mov_b32 v122, s61
    ds_write_b32 v121, v122 offset:2880
    s_setprio 0
    s_cmp_ge_u32 s31, 9
    s_cbranch_scc1 L_W_role2
    s_mul_i32 s53, s57, 4736
    s_add_u32 s53, s53, 860160
    v_lshlrev_b32 v120, 7, v1
    s_mov_b32 exec_hi, 0xf
    buffer_load_dword v8, v120, s[32:35], s53 offen sc1
    s_mov_b64 exec, -1
    buffer_load_dword v9, v120, s[40:43], 0 offen
    s_branch L_W_role2
L_warm_done:
    s_mov_b64 exec, -1
    s_waitcnt lgkmcnt(0)
    s_mul_i32 s48, s48, 1664525
    s_add_u32 s48, s48, 1013904223
    v_and_b32 v8, 1, v1
    v_lshlrev_b32 v8, 4, v8
    v_mov_b32 v9, 0xffff
    v_lshlrev_b32 v8, v8, v9
    v_bfe_u32 v9, v1, 1, 2
    v_cmp_eq_u32 vcc, 0, v9
    s_nop 1
    v_cndmask_b32 v4, 0, v8, vcc
    v_cmp_eq_u32 vcc, 1, v9
    s_nop 1
    v_cndmask_b32 v5, 0, v8, vcc
    v_cmp_eq_u32 vcc, 2, v9
    s_nop 1
    v_cndmask_b32 v6, 0, v8, vcc
    v_cmp_eq_u32 vcc, 3, v9
    s_nop 1
    v_cndmask_b32 v7, 0, v8, vcc
    s_cmp_lg_u32 s63, 1
    s_cbranch_scc1 L_W_role2
    s_mov_b32 s40, s12
    s_mov_b32 s41, s13
    s_mov_b32 s42, 0x480000
    s_mov_b32 s43, 0x20000
    v_lshlrev_b32 v12, 7, v1
    s_lshl_b32 s52, s49, 4
    s_add_u32 s52, s52, s50
    s_mul_i32 s52, s52, 18432
    s_add_u32 s53, s52, 8192
    s_add_u32 s54, s52, 16384
    v_and_b32 v10, 7, v1
    v_lshlrev_b32 v10, 2, v10
L_fl_59:
    ds_read_b32 v11, v10 offset:2848
    s_waitcnt lgkmcnt(0)
    v_cmp_eq_u32 vcc, 0, v11
    s_cbranch_vccz L_fld_60
    s_sleep 1
    s_sub_u32 s60, s60, 1
    s_cmp_lg_u32 s60, 0
    s_cbranch_scc1 L_fl_59
    s_branch L_exit
L_fld_60:
    buffer_load_dword v13, v12, s[40:43], s52 offen
    buffer_load_dword v14, v12, s[40:43], s53 offen
    s_mov_b64 exec, 0xffff
    buffer_load_dword v15, v12, s[40:43], s54 offen
    s_mov_b64 exec, -1
L_W_role2:
    s_cmp_ge_u32 s31, 18
    s_cbranch_scc1 L_help
    s_cmp_ge_u32 s31, 9
    s_cbranch_scc1 L_wo
    s_mov_b32 s36, s18
    s_mov_b32 s37, s19
    s_mov_b32 s38, 0x510000
    s_mov_b32 s39, 0x20000
    s_mov_b32 s40, s20
    s_mov_b32 s41, s21
    s_mov_b32 s42, 0x510000
    s_mov_b32 s43, 0x20000
    v_bfe_u32 v121, v1, 3, 1
    v_lshl_add_u32 v121, v121, 2, v3
    v_mul_u32_u24 v122, 9216, v121
    v_and_b32 v123, 7, v1
    v_lshl_add_u32 v122, v123, 4, v122
    s_mul_i32 s54, s63, 73728
    s_lshl_b32 s53, s57, 7
    s_add_u32 s54, s54, s53
    s_cmp_lg_u32 s63, 2
    s_cbranch_scc1 L_nowarm4
    v_lshlrev_b32 v16, 7, v1
    s_lshl_b32 s61, s31, 12
    s_add_u32 s61, s61, 819200
    s_mov_b32 exec_hi, 0
    buffer_load_dword v17, v16, s[32:35], s61 offen sc1
    s_mov_b64 exec, -1
L_nowarm4:
    v_and_b32 v10, 0, v1
    v_lshlrev_b32 v10, 2, v10
L_fl_61:
    ds_read_b32 v11, v10 offset:2884
    s_waitcnt lgkmcnt(0)
    v_cmp_eq_u32 vcc, 0, v11
    s_cbranch_vccz L_fld_62
    s_sleep 1
    s_sub_u32 s60, s60, 1
    s_cmp_lg_u32 s60, 0
    s_cbranch_scc1 L_fl_61
    s_branch L_exit
L_fld_62:
    buffer_load_dwordx4 v[32:35], v122, s[36:39], s54 offen nt
    buffer_load_dwordx4 v[36:39], v122, s[40:43], s54 offen nt
    s_add_u32 s54, s54, 589824
    buffer_load_dwordx4 v[40:43], v122, s[36:39], s54 offen nt
    buffer_load_dwordx4 v[44:47], v122, s[40:43], s54 offen nt
    s_add_u32 s54, s54, 589824
    s_waitcnt vmcnt(2)
    buffer_load_dwordx4 v[48:51], v122, s[36:39], s54 offen nt
    buffer_load_dwordx4 v[52:55], v122, s[40:43], s54 offen nt
    s_add_u32 s54, s54, 589824
    s_waitcnt vmcnt(2)
    buffer_load_dwordx4 v[56:59], v122, s[36:39], s54 offen nt
    buffer_load_dwordx4 v[60:63], v122, s[40:43], s54 offen nt
    s_add_u32 s54, s54, 589824
    s_waitcnt vmcnt(2)
    buffer_load_dwordx4 v[64:67], v122, s[36:39], s54 offen nt
    buffer_load_dwordx4 v[68:71], v122, s[40:43], s54 offen nt
    s_add_u32 s54, s54, 589824
    s_waitcnt vmcnt(2)
    buffer_load_dwordx4 v[72:75], v122, s[36:39], s54 offen nt
    buffer_load_dwordx4 v[76:79], v122, s[40:43], s54 offen nt
    s_add_u32 s54, s54, 589824
    s_waitcnt vmcnt(2)
    buffer_load_dwordx4 v[80:83], v122, s[36:39], s54 offen nt
    buffer_load_dwordx4 v[84:87], v122, s[40:43], s54 offen nt
    s_add_u32 s54, s54, 589824
    s_waitcnt vmcnt(2)
    buffer_load_dwordx4 v[88:91], v122, s[36:39], s54 offen nt
    buffer_load_dwordx4 v[92:95], v122, s[40:43], s54 offen nt
    s_add_u32 s54, s54, 589824
    s_waitcnt vmcnt(2)
    buffer_load_dwordx4 v[96:99], v122, s[36:39], s54 offen nt
    buffer_load_dwordx4 v[100:103], v122, s[40:43], s54 offen nt
    v_mov_b32 v10, 0
    v_mov_b32 v11, 1
    s_mov_b64 exec, 1
    ds_add_u32 v10, v11 offset:2892
    s_mov_b64 exec, -1
    v_and_b32 v122, 7, v1
    v_lshlrev_b32 v122, 2, v122
    v_bfe_u32 v123, v1, 4, 1
    v_lshl_add_u32 v122, v123, 1, v122
    v_lshrrev_b32 v123, 5, v1
    v_add_u32 v122, v122, v123
    s_lshl_b32 s52, s63, 9
    v_lshl_add_u32 v123, v122, 3, s52
    s_lshl_b32 s52, s63, 5
    v_lshl_add_u32 v124, v121, 2, s52
    v_mov_b32 v125, 0
    v_mov_b32 v126, 1
    v_and_b32 v104, 0x3f803f80, v4
    v_and_b32 v105, 0x3f803f80, v5
    v_and_b32 v106, 0x3f803f80, v6
    v_and_b32 v107, 0x3f803f80, v7
    s_waitcnt vmcnt(16)
    s_nop 0
    v_mfma_f32_16x16x32_bf16 v[112:115], v[104:107], v[32:35], 0
    v_mfma_f32_16x16x32_bf16 v[116:119], v[104:107], v[36:39], 0
    s_waitcnt vmcnt(14)
    v_mfma_f32_16x16x32_bf16 v[112:115], v[104:107], v[40:43], v[112:115]
    v_mfma_f32_16x16x32_bf16 v[116:119], v[104:107], v[44:47], v[116:119]
    s_waitcnt vmcnt(12)
    v_mfma_f32_16x16x32_bf16 v[112:115], v[104:107], v[48:51], v[112:115]
    v_mfma_f32_16x16x32_bf16 v[116:119], v[104:107], v[52:55], v[116:119]
    s_waitcnt vmcnt(10)
    v_mfma_f32_16x16x32_bf16 v[112:115], v[104:107], v[56:59], v[112:115]
    v_mfma_f32_16x16x32_bf16 v[116:119], v[104:107], v[60:63], v[116:119]
    s_waitcnt vmcnt(8)
    v_mfma_f32_16x16x32_bf16 v[112:115], v[104:107], v[64:67], v[112:115]
    v_mfma_f32_16x16x32_bf16 v[116:119], v[104:107], v[68:71], v[116:119]
    s_waitcnt vmcnt(6)
    v_mfma_f32_16x16x32_bf16 v[112:115], v[104:107], v[72:75], v[112:115]
    v_mfma_f32_16x16x32_bf16 v[116:119], v[104:107], v[76:79], v[116:119]
    s_waitcnt vmcnt(4)
    v_mfma_f32_16x16x32_bf16 v[112:115], v[104:107], v[80:83], v[112:115]
    v_mfma_f32_16x16x32_bf16 v[116:119], v[104:107], v[84:87], v[116:119]
    s_waitcnt vmcnt(2)
    v_mfma_f32_16x16x32_bf16 v[112:115], v[104:107], v[88:91], v[112:115]
    v_mfma_f32_16x16x32_bf16 v[116:119], v[104:107], v[92:95], v[116:119]
    s_waitcnt vmcnt(0)
    v_mfma_f32_16x16x32_bf16 v[112:115], v[104:107], v[96:99], v[112:115]
    v_mfma_f32_16x16x32_bf16 v[116:119], v[104:107], v[100:103], v[116:119]
    s_nop 6
    v_permlane32_swap_b32 v112, v114
    v_permlane32_swap_b32 v113, v115
    s_nop 0
    v_add_f32_dpp v8, v114, v112 row_ror:8 row_mask:0xf bank_mask:0xf
    v_add_f32_dpp v9, v115, v113 row_ror:8 row_mask:0xf bank_mask:0xf
    v_permlane32_swap_b32 v116, v118
    v_permlane32_swap_b32 v117, v119
    s_nop 0
    v_add_f32_dpp v10, v118, v116 row_ror:8 row_mask:0xf bank_mask:0xf
    v_add_f32_dpp v11, v119, v117 row_ror:8 row_mask:0xf bank_mask:0xf
    s_mov_b64 exec, s[58:59]
    ds_write_b64 v123, v[8:9] offset:17408
    ds_write_b64 v123, v[10:11] offset:17664
    s_mov_b64 exec, -1
    s_setprio 2
    s_waitcnt lgkmcnt(0)
    s_barrier
    ds_read2st64_b32 v[16:17], v124 offset0:0 offset1:1
    ds_read2st64_b32 v[18:19], v124 offset0:2 offset1:3
    ds_read2st64_b32 v[20:21], v124 offset0:4 offset1:5
    ds_read2st64_b32 v[22:23], v124 offset0:6 offset1:7
    ds_read_b32 v24, v124 offset:2048
    s_waitcnt lgkmcnt(0)
    v_and_b32 v104, v16, v4
    v_and_b32 v105, v16, v5
    v_and_b32 v106, v16, v6
    v_and_b32 v107, v16, v7
    v_and_b32 v108, v17, v4
    v_and_b32 v109, v17, v5
    v_mfma_f32_16x16x32_bf16 v[112:115], v[104:107], v[32:35], 0
    v_and_b32 v110, v17, v6
    v_and_b32 v111, v17, v7
    v_mfma_f32_16x16x32_bf16 v[116:119], v[104:107], v[36:39], 0
    v_and_b32 v104, v18, v4
    v_and_b32 v105, v18, v5
    v_mfma_f32_16x16x32_bf16 v[112:115], v[108:111], v[40:43], v[112:115]
    v_and_b32 v106, v18, v6
    v_and_b32 v107, v18, v7
    v_mfma_f32_16x16x32_bf16 v[116:119], v[108:111], v[44:47], v[116:119]
    v_and_b32 v108, v19, v4
    v_and_b32 v109, v19, v5
    v_mfma_f32_16x16x32_bf16 v[112:115], v[104:107], v[48:51], v[112:115]
    v_and_b32 v110, v19, v6
    v_and_b32 v111, v19, v7
    v_mfma_f32_16x16x32_bf16 v[116:119], v[104:107], v[52:55], v[116:119]
    v_and_b32 v104, v20, v4
    v_and_b32 v105, v20, v5
    v_mfma_f32_16x16x32_bf16 v[112:115], v[108:111], v[56:59], v[112:115]
    v_and_b32 v106, v20, v6
    v_and_b32 v107, v20, v7
    v_mfma_f32_16x16x32_bf16 v[116:119], v[108:111], v[60:63], v[116:119]
    v_and_b32 v108, v21, v4
    v_and_b32 v109, v21, v5
    v_mfma_f32_16x16x32_bf16 v[112:115], v[104:107], v[64:67], v[112:115]
    v_and_b32 v110, v21, v6
    v_and_b32 v111, v21, v7
    v_mfma_f32_16x16x32_bf16 v[116:119], v[104:107], v[68:71], v[116:119]
    v_and_b32 v104, v22, v4
    v_and_b32 v105, v22, v5
    v_mfma_f32_16x16x32_bf16 v[112:115], v[108:111], v[72:75], v[112:115]
    v_and_b32 v106, v22, v6
    v_and_b32 v107, v22, v7
    v_mfma_f32_16x16x32_bf16 v[116:119], v[108:111], v[76:79], v[116:119]
    v_and_b32 v108, v23, v4
    v_and_b32 v109, v23, v5
    v_mfma_f32_16x16x32_bf16 v[112:115], v[104:107], v[80:83], v[112:115]
    v_and_b32 v110, v23, v6
    v_and_b32 v111, v23, v7
    v_mfma_f32_16x16x32_bf16 v[116:119], v[104:107], v[84:87], v[116:119]
    v_and_b32 v104, v24, v4
    v_and_b32 v105, v24, v5
    v_mfma_f32_16x16x32_bf16 v[112:115], v[108:111], v[88:91], v[112:115]
    v_and_b32 v106, v24, v6
    v_and_b32 v107, v24, v7
    v_mfma_f32_16x16x32_bf16 v[116:119], v[108:111], v[92:95], v[116:119]
    s_nop 0
    v_mfma_f32_16x16x32_bf16 v[112:115], v[104:107], v[96:99], v[112:115]
    v_mfma_f32_16x16x32_bf16 v[116:119], v[104:107], v[100:103], v[116:119]
    s_nop 6
    v_permlane32_swap_b32 v112, v114
    v_permlane32_swap_b32 v113, v115
    s_nop 0
    v_add_f32_dpp v8, v114, v112 row_ror:8 row_mask:0xf bank_mask:0xf
    v_add_f32_dpp v9, v115, v113 row_ror:8 row_mask:0xf bank_mask:0xf
    v_permlane32_swap_b32 v116, v118
    v_permlane32_swap_b32 v117, v119
    s_nop 0
    v_add_f32_dpp v10, v118, v116 row_ror:8 row_mask:0xf bank_mask:0xf
    v_add_f32_dpp v11, v119, v117 row_ror:8 row_mask:0xf bank_mask:0xf
    s_mov_b64 exec, s[58:59]
    ds_write_b64 v123, v[8:9] offset:11264
    ds_write_b64 v123, v[10:11] offset:11520
    s_mov_b64 exec, -1
    s_waitcnt lgkmcnt(0)
    s_barrier
    s_cmp_lg_u32 s63, 0
    s_cbranch_scc1 L_exit
    s_setprio 0
    s_mov_b32 s44, s24
    s_mov_b32 s45, s25
    s_mov_b32 s46, 0x480
    s_mov_b32 s47, 0x20000
    s_mov_b32 s36, s16
    s_mov_b32 s37, s17
    s_mov_b32 s38, 0x480
    s_mov_b32 s39, 0x20000
    v_lshlrev_b32 v15, 1, v1
    buffer_load_ushort v100, v15, s[36:39], 0 offen offset:0
    buffer_load_ushort v101, v15, s[36:39], 0 offen offset:128
    buffer_load_ushort v102, v15, s[36:39], 0 offen offset:256
    buffer_load_ushort v103, v15, s[36:39], 0 offen offset:384
    buffer_load_ushort v104, v15, s[36:39], 0 offen offset:512
    buffer_load_ushort v105, v15, s[36:39], 0 offen offset:640
    buffer_load_ushort v106, v15, s[36:39], 0 offen offset:768
    buffer_load_ushort v107, v15, s[36:39], 0 offen offset:896
    buffer_load_ushort v108, v15, s[36:39], 0 offen offset:1024
    s_lshr_b32 s61, s57, 2
    s_lshl_b32 s61, s61, 5
    s_and_b32 s62, s57, 1
    s_lshl_b32 s62, s62, 2
    s_add_u32 s61, s61, s62
    s_and_b32 s62, s57, 2
    s_add_u32 s61, s61, s62
    v_and_b32 v12, 3, v1
    v_lshlrev_b32 v12, 3, v12
    v_lshrrev_b32 v13, 5, v1
    v_add3_u32 v12, v12, v13, s61
    v_lshlrev_b32 v14, 2, v12
    v_lshlrev_b32 v15, 2, v1
    ds_read2st64_b32 v[64:65], v15 offset0:0 offset1:1
    ds_read2st64_b32 v[66:67], v15 offset0:2 offset1:3
    ds_read2st64_b32 v[68:69], v15 offset0:4 offset1:5
    ds_read2st64_b32 v[70:71], v15 offset0:6 offset1:7
    ds_read_b32 v72, v15 offset:2048
    ds_read_b32 v73, v14 offset:0
    ds_read_b64 v[76:77], v125 offset:2928
    v_lshlrev_b32 v97, 4, v1
    s_mul_i32 s53, s57, 4736
    s_add_u32 s53, s53, 860160
    s_add_u32 s54, s53, 4096
    v_mov_b32 v48, 0
    v_mov_b32 v49, s48
    v_mov_b32 v50, 0
    v_mov_b32 v51, s48
    v_lshlrev_b32 v12, 1, v12
    s_waitcnt lgkmcnt(0)
    v_and_b32 v64, 0xffff0000, v64
    v_and_b32 v65, 0xffff0000, v65
    v_and_b32 v66, 0xffff0000, v66
    v_and_b32 v67, 0xffff0000, v67
    v_and_b32 v68, 0xffff0000, v68
    v_and_b32 v69, 0xffff0000, v69
    v_and_b32 v70, 0xffff0000, v70
    v_and_b32 v71, 0xffff0000, v71
    v_and_b32 v72, 0xffff0000, v72
    v_and_b32 v73, 0xffff0000, v73
    v_mov_b32 v20, v73
    v_sub_f32 v64, v64, v76
    v_sub_f32 v65, v65, v76
    v_sub_f32 v66, v66, v76
    v_sub_f32 v67, v67, v76
    v_sub_f32 v68, v68, v76
    v_sub_f32 v69, v69, v76
    v_sub_f32 v70, v70, v76
    v_sub_f32 v71, v71, v76
    v_sub_f32 v72, v72, v76
    v_sub_f32 v73, v73, v76
    v_cvt_pk_bf16_f32 v64, v64, v64
    v_cvt_pk_bf16_f32 v65, v65, v65
    v_cvt_pk_bf16_f32 v66, v66, v66
    v_cvt_pk_bf16_f32 v67, v67, v67
    v_cvt_pk_bf16_f32 v68, v68, v68
    v_cvt_pk_bf16_f32 v69, v69, v69
    v_cvt_pk_bf16_f32 v70, v70, v70
    v_cvt_pk_bf16_f32 v71, v71, v71
    v_cvt_pk_bf16_f32 v72, v72, v72
    v_cvt_pk_bf16_f32 v73, v73, v73
    v_and_b32 v64, 0xffff0000, v64
    v_and_b32 v65, 0xffff0000, v65
    v_and_b32 v66, 0xffff0000, v66
    v_and_b32 v67, 0xffff0000, v67
    v_and_b32 v68, 0xffff0000, v68
    v_and_b32 v69, 0xffff0000, v69
    v_and_b32 v70, 0xffff0000, v70
    v_and_b32 v71, 0xffff0000, v71
    v_and_b32 v72, 0xffff0000, v72
    v_and_b32 v73, 0xffff0000, v73
    v_mul_f32 v64, v64, v77
    v_mul_f32 v65, v65, v77
    v_mul_f32 v66, v66, v77
    v_mul_f32 v67, v67, v77
    v_mul_f32 v68, v68, v77
    v_mul_f32 v69, v69, v77
    v_mul_f32 v70, v70, v77
    v_mul_f32 v71, v71, v77
    v_mul_f32 v72, v72, v77
    v_mul_f32 v73, v73, v77
    v_cvt_pk_bf16_f32 v64, v64, v64
    v_cvt_pk_bf16_f32 v65, v65, v65
    v_cvt_pk_bf16_f32 v66, v66, v66
    v_cvt_pk_bf16_f32 v67, v67, v67
    v_cvt_pk_bf16_f32 v68, v68, v68
    v_cvt_pk_bf16_f32 v69, v69, v69
    v_cvt_pk_bf16_f32 v70, v70, v70
    v_cvt_pk_bf16_f32 v71, v71, v71
    v_cvt_pk_bf16_f32 v72, v72, v72
    v_cvt_pk_bf16_f32 v73, v73, v73
    v_mov_b32 v22, 0
    s_waitcnt vmcnt(0)
    v_and_b32 v23, 0xffff0000, v64
    v_lshlrev_b32 v24, 16, v100
    v_fmac_f32 v22, v23, v24
    v_and_b32 v23, 0xffff0000, v65
    v_lshlrev_b32 v24, 16, v101
    v_fmac_f32 v22, v23, v24
    v_and_b32 v23, 0xffff0000, v66
    v_lshlrev_b32 v24, 16, v102
    v_fmac_f32 v22, v23, v24
    v_and_b32 v23, 0xffff0000, v67
    v_lshlrev_b32 v24, 16, v103
    v_fmac_f32 v22, v23, v24
    v_and_b32 v23, 0xffff0000, v68
    v_lshlrev_b32 v24, 16, v104
    v_fmac_f32 v22, v23, v24
    v_and_b32 v23, 0xffff0000, v69
    v_lshlrev_b32 v24, 16, v105
    v_fmac_f32 v22, v23, v24
    v_and_b32 v23, 0xffff0000, v70
    v_lshlrev_b32 v24, 16, v106
    v_fmac_f32 v22, v23, v24
    v_and_b32 v23, 0xffff0000, v71
    v_lshlrev_b32 v24, 16, v107
    v_fmac_f32 v22, v23, v24
    v_and_b32 v23, 0xffff0000, v72
    v_lshlrev_b32 v24, 16, v108
    v_fmac_f32 v22, v23, v24
    s_nop 1
    v_add_f32_dpp v22, v22, v22 row_ror:8 row_mask:0xf bank_mask:0xf
    s_nop 1
    v_add_f32_dpp v22, v22, v22 row_ror:4 row_mask:0xf bank_mask:0xf
    s_nop 1
    v_add_f32_dpp v22, v22, v22 row_ror:2 row_mask:0xf bank_mask:0xf
    s_nop 1
    v_add_f32_dpp v22, v22, v22 row_ror:1 row_mask:0xf bank_mask:0xf
    v_mov_b32 v23, v22
    s_nop 1
    v_permlane16_swap_b32 v22, v23
    v_add_f32 v22, v22, v23
    v_mov_b32 v23, v22
    s_nop 1
    v_permlane32_swap_b32 v22, v23
    v_add_f32 v22, v22, v23
    v_cvt_pk_bf16_f32 v22, v22, v22
    v_and_b32 v22, 0xffff0000, v22
    v_mul_f32 v22, 0xbfb8aa3b, v22
    v_exp_f32 v22, v22
    s_nop 0
    v_add_f32 v22, 1.0, v22
    v_rcp_f32 v22, v22
    s_nop 0
    v_cvt_pk_bf16_f32 v22, v22, v22
    v_and_b32 v22, 0xffff0000, v22
    v_and_b32 v21, 0xffff0000, v73
L_h5_63:
    buffer_load_dwordx4 v[32:35], v97, s[32:35], s53 offen offset:0 sc1
    buffer_load_dwordx4 v[36:39], v97, s[32:35], s53 offen offset:1024 sc1
    buffer_load_dwordx4 v[40:43], v97, s[32:35], s53 offen offset:2048 sc1
    buffer_load_dwordx4 v[44:47], v97, s[32:35], s53 offen offset:3072 sc1
    s_mov_b32 exec_hi, 0
    buffer_load_dwordx4 v[48:51], v97, s[32:35], s54 offen sc1
    s_mov_b64 exec, -1
    s_waitcnt vmcnt(0)
    v_xor_b32 v14, s48, v33
    v_bitop3_b32 v14, v14, v35, s48 bitop3:0xf6
    v_bitop3_b32 v14, v14, v37, s48 bitop3:0xf6
    v_bitop3_b32 v14, v14, v39, s48 bitop3:0xf6
    v_bitop3_b32 v14, v14, v41, s48 bitop3:0xf6
    v_bitop3_b32 v14, v14, v43, s48 bitop3:0xf6
    v_bitop3_b32 v14, v14, v45, s48 bitop3:0xf6
    v_bitop3_b32 v14, v14, v47, s48 bitop3:0xf6
    v_bitop3_b32 v14, v14, v49, s48 bitop3:0xf6
    v_bitop3_b32 v14, v14, v51, s48 bitop3:0xf6
    v_cmp_ne_u32 vcc, 0, v14
    s_cbranch_vccz L_h5d_64
    s_sub_u32 s60, s60, 1
    s_cmp_lg_u32 s60, 0
    s_cbranch_scc1 L_h5_63
    s_branch L_exit
L_h5d_64:
    v_add_f32 v32, v32, v36
    v_add_f32 v34, v34, v38
    v_add_f32 v40, v40, v44
    v_add_f32 v42, v42, v46
    v_add_f32 v32, v32, v48
    v_add_f32 v34, v34, v50
    v_add_f32 v32, v32, v40
    v_add_f32 v34, v34, v42
    s_nop 1
    v_permlane32_swap_b32 v32, v34
    v_add_f32 v32, v32, v34
    s_nop 1
    v_add_f32_dpp v32, v32, v32 row_ror:8 row_mask:0xf bank_mask:0xf
    s_nop 1
    v_add_f32_dpp v32, v32, v32 row_ror:4 row_mask:0xf bank_mask:0xf
    v_mov_b32 v13, v32
    s_nop 1
    v_permlane16_swap_b32 v32, v13
    v_add_f32 v32, v32, v13
    v_cvt_pk_bf16_f32 v32, v32, v32
    v_and_b32 v32, 0xffff0000, v32
    v_mul_f32 v32, v22, v32
    v_cvt_pk_bf16_f32 v32, v32, v32
    v_and_b32 v32, 0xffff0000, v32
    v_add_f32 v32, v21, v32
    v_cvt_pk_bf16_f32 v32, v32, v32
    v_and_b32 v32, 0xffff0000, v32
    v_add_f32 v32, v20, v32
    v_cvt_pk_bf16_f32 v32, v32, v32
    s_mov_b32 exec_lo, 0xf
    s_mov_b32 exec_hi, 0xf
    buffer_store_short v32, v12, s[44:47], 0 offen
    s_cmp_lg_u32 s57, 0
    s_cbranch_scc1 L_fin
    s_mov_b64 exec, 1
    buffer_store_dword v33, v97, s[32:35], 0 offen sc1
L_fin:
    s_branch L_exit
L_wo:
    s_sub_u32 s57, s31, 9
    s_lshr_b32 s62, s63, 2
    s_lshl_b32 s62, s62, 5
    s_and_b32 s61, s63, 3
    s_add_u32 s61, s61, s62
    s_lshl_b32 s62, s30, 2
    s_add_u32 s51, s61, s62
    s_mov_b32 s40, s12
    s_mov_b32 s41, s13
    s_mov_b32 s42, 0x480000
    s_mov_b32 s43, 0x20000
    s_mov_b32 s44, s4
    s_mov_b32 s45, s5
    s_mov_b32 s46, 0x480
    s_mov_b32 s47, 0x20000
    v_bfe_u32 v121, v1, 3, 1
    v_lshl_add_u32 v121, v121, 2, v3
    v_bfrev_b32 v122, v121
    v_lshrrev_b32 v122, 29, v122
    v_mul_u32_u24 v122, 1152, v122
    v_and_b32 v123, 7, v1
    v_lshl_add_u32 v122, v123, 4, v122
    s_mul_i32 s52, s51, 73728
    s_lshl_b32 s53, s57, 7
    s_add_u32 s52, s52, s53
    v_lshlrev_b32 v124, 2, v1
    buffer_load_dword v28, v124, s[44:47], s53 offen
    s_mul_i32 s88, s51, 10368
    s_add_u32 s88, s88, 147456
    s_add_u32 s90, s88, 8192
    s_lshl_b32 s89, s30, 12
    s_lshl_b32 s61, s63, 9
    s_add_u32 s89, s89, s61
    s_add_u32 s89, s89, 1376256
    v_lshlrev_b32 v120, 4, v1
    v_lshlrev_b32 v125, 6, v121
    s_lshl_b32 s61, s63, 8
    v_and_b32 v123, 7, v1
    v_lshlrev_b32 v123, 2, v123
    v_bfe_u32 v16, v1, 4, 1
    v_lshl_add_u32 v123, v16, 1, v123
    v_lshrrev_b32 v16, 5, v1
    v_add_u32 v123, v123, v16
    v_lshl_add_u32 v123, v123, 3, s61
    s_lshl_b32 s55, s57, 12
    s_lshl_b32 s61, s30, 9
    s_add_u32 s55, s55, s61
    s_add_u32 s55, s55, 819200
    v_mov_b32 v117, s48
    v_mov_b32 v119, s48
    s_cmp_lg_u32 s63, s57
    s_cbranch_scc1 L_nowarm
    v_lshlrev_b32 v16, 7, v1
    buffer_load_dword v17, v16, s[32:35], s88 offen sc1
    s_mov_b64 exec, 0xffff
    buffer_load_dword v18, v16, s[32:35], s90 offen sc1
    s_mov_b64 exec, 0xf
    buffer_load_dword v19, v16, s[32:35], s89 offen sc1
    s_mov_b64 exec, -1
L_nowarm:
    v_and_b32 v10, 0, v1
    v_lshlrev_b32 v10, 2, v10
L_fl_65:
    ds_read_b32 v11, v10 offset:2884
    s_waitcnt lgkmcnt(0)
    v_cmp_eq_u32 vcc, 0, v11
    s_cbranch_vccz L_fld_66
    s_sleep 1
    s_sub_u32 s60, s60, 1
    s_cmp_lg_u32 s60, 0
    s_cbranch_scc1 L_fl_65
    s_branch L_exit
L_fld_66:
    buffer_load_dwordx4 v[32:35], v122, s[40:43], s52 offen nt
    s_add_u32 s52, s52, 9216
    buffer_load_dwordx4 v[36:39], v122, s[40:43], s52 offen nt
    s_add_u32 s52, s52, 9216
    buffer_load_dwordx4 v[40:43], v122, s[40:43], s52 offen nt
    s_add_u32 s52, s52, 9216
    buffer_load_dwordx4 v[44:47], v122, s[40:43], s52 offen nt
    s_add_u32 s52, s52, 9216
    buffer_load_dwordx4 v[48:51], v122, s[40:43], s52 offen nt
    s_add_u32 s52, s52, 9216
    buffer_load_dwordx4 v[52:55], v122, s[40:43], s52 offen nt
    s_add_u32 s52, s52, 9216
    buffer_load_dwordx4 v[56:59], v122, s[40:43], s52 offen nt
    s_add_u32 s52, s52, 9216
    buffer_load_dwordx4 v[60:63], v122, s[40:43], s52 offen nt
    v_mov_b32 v10, 0
    v_mov_b32 v11, 1
    s_mov_b64 exec, 1
    ds_add_u32 v10, v11 offset:2888
    s_mov_b64 exec, -1
    s_cmp_eq_u32 s57, 8
    s_cbranch_scc1 L_ho_go
    v_mov_b32 v10, 0
L_ct_67:
    ds_read_b32 v11, v10 offset:2892
    s_waitcnt lgkmcnt(0)
    v_cmp_gt_u32 vcc, 1, v11
    s_cbranch_vccz L_ctd_68
    s_sleep 1
    s_sub_u32 s60, s60, 1
    s_cmp_lg_u32 s60, 0
    s_cbranch_scc1 L_ct_67
    s_branch L_exit
L_ctd_68:
L_ho_go:
L_ho_69:
    buffer_load_dwordx4 v[64:67], v125, s[32:35], s89 offen offset:0 sc1
    buffer_load_dwordx4 v[68:71], v125, s[32:35], s89 offen offset:16 sc1
    buffer_load_dwordx4 v[72:75], v125, s[32:35], s89 offen offset:32 sc1
    buffer_load_dwordx4 v[76:79], v125, s[32:35], s89 offen offset:48 sc1
    s_waitcnt vmcnt(0)
    v_xor_b32 v16, s48, v65
    v_bitop3_b32 v16, v16, v67, s48 bitop3:0xf6
    v_bitop3_b32 v16, v16, v69, s48 bitop3:0xf6
    v_bitop3_b32 v16, v16, v71, s48 bitop3:0xf6
    v_bitop3_b32 v16, v16, v73, s48 bitop3:0xf6
    v_bitop3_b32 v16, v16, v75, s48 bitop3:0xf6
    v_bitop3_b32 v16, v16, v77, s48 bitop3:0xf6
    v_bitop3_b32 v16, v16, v79, s48 bitop3:0xf6
    v_cmp_ne_u32 vcc, 0, v16
    s_cbranch_vccz L_hod_70
    s_sub_u32 s60, s60, 1
    s_cmp_lg_u32 s60, 0
    s_cbranch_scc1 L_ho_69
    s_branch L_exit
L_hod_70:
    v_and_b32 v104, v64, v4
    v_and_b32 v105, v64, v5
    v_and_b32 v106, v64, v6
    v_and_b32 v107, v64, v7
    v_and_b32 v108, v66, v4
    v_and_b32 v109, v66, v5
    v_and_b32 v110, v66, v6
    v_and_b32 v111, v66, v7
    v_mfma_f32_16x16x32_bf16 v[112:115], v[104:107], v[32:35], 0
    v_and_b32 v104, v68, v4
    v_and_b32 v105, v68, v5
    v_and_b32 v106, v68, v6
    v_and_b32 v107, v68, v7
    v_mfma_f32_16x16x32_bf16 v[112:115], v[108:111], v[36:39], v[112:115]
    v_and_b32 v108, v70, v4
    v_and_b32 v109, v70, v5
    v_and_b32 v110, v70, v6
    v_and_b32 v111, v70, v7
    v_mfma_f32_16x16x32_bf16 v[112:115], v[104:107], v[40:43], v[112:115]
    v_and_b32 v104, v72, v4
    v_and_b32 v105, v72, v5
    v_and_b32 v106, v72, v6
    v_and_b32 v107, v72, v7
    v_mfma_f32_16x16x32_bf16 v[112:115], v[108:111], v[44:47], v[112:115]
    v_and_b32 v108, v74, v4
    v_and_b32 v109, v74, v5
    v_and_b32 v110, v74, v6
    v_and_b32 v111, v74, v7
    v_mfma_f32_16x16x32_bf16 v[112:115], v[104:107], v[48:51], v[112:115]
    v_and_b32 v104, v76, v4
    v_and_b32 v105, v76, v5
    v_and_b32 v106, v76, v6
    v_and_b32 v107, v76, v7
    v_mfma_f32_16x16x32_bf16 v[112:115], v[108:111], v[52:55], v[112:115]
    v_and_b32 v108, v78, v4
    v_and_b32 v109, v78, v5
    v_and_b32 v110, v78, v6
    v_and_b32 v111, v78, v7
    v_mfma_f32_16x16x32_bf16 v[112:115], v[104:107], v[56:59], v[112:115]
    s_nop 0
    v_mfma_f32_16x16x32_bf16 v[112:115], v[108:111], v[60:63], v[112:115]
    s_nop 7
    v_permlane32_swap_b32 v112, v114
    v_permlane32_swap_b32 v113, v115
    s_nop 0
    v_add_f32_dpp v8, v114, v112 row_ror:8 row_mask:0xf bank_mask:0xf
    v_add_f32_dpp v9, v115, v113 row_ror:8 row_mask:0xf bank_mask:0xf
    s_mov_b64 exec, s[58:59]
    ds_write_b64 v123, v[8:9] offset:11264
    s_mov_b64 exec, -1
    v_lshlrev_b32 v124, 3, v1
    v_lshlrev_b32 v26, 16, v28
    v_and_b32 v27, 0xffff0000, v28
    s_waitcnt lgkmcnt(0)
    s_barrier
    s_cmp_lg_u32 s63, 0
    s_cbranch_scc1 L_exit
    s_mov_b32 exec_hi, 0
    ds_read_b64 v[8:9], v124 offset:11264
    ds_read_b64 v[10:11], v124 offset:11520
    ds_read_b64 v[12:13], v124 offset:11776
    ds_read_b64 v[14:15], v124 offset:12032
    ds_read_b64 v[16:17], v124 offset:12288
    ds_read_b64 v[18:19], v124 offset:12544
    ds_read_b64 v[20:21], v124 offset:12800
    ds_read_b64 v[22:23], v124 offset:13056
    s_cmp_eq_u32 s30, 0
    s_cbranch_scc1 L_addx
    v_mov_b32 v26, 0
    v_mov_b32 v27, 0
L_addx:
    s_waitcnt lgkmcnt(0)
    v_pk_add_f32 v[8:9], v[8:9], v[10:11]
    v_pk_add_f32 v[12:13], v[12:13], v[14:15]
    v_pk_add_f32 v[16:17], v[16:17], v[18:19]
    v_pk_add_f32 v[20:21], v[20:21], v[22:23]
    v_pk_add_f32 v[8:9], v[8:9], v[12:13]
    v_pk_add_f32 v[16:17], v[16:17], v[20:21]
    v_pk_add_f32 v[8:9], v[8:9], v[16:17]
    v_add_f32 v116, v8, v26
    v_add_f32 v118, v9, v27
    buffer_store_dwordx4 v[116:119], v120, s[32:35], s55 offen sc1
    s_branch L_exit
L_help:
    s_cmp_lg_u32 s63, 1
    s_cbranch_scc1 L_exit
    s_mov_b32 s36, s18
    s_mov_b32 s37, s19
    s_mov_b32 s38, 0x510000
    s_mov_b32 s39, 0x20000
    s_mov_b32 s40, s20
    s_mov_b32 s41, s21
    s_mov_b32 s42, 0x510000
    s_mov_b32 s43, 0x20000
    s_mov_b32 s44, s22
    s_mov_b32 s45, s23
    s_mov_b32 s46, 0x510000
    s_mov_b32 s47, 0x20000
    s_mov_b32 s52, 477218589
    v_mul_hi_u32 v12, v1, s52
    v_mul_u32_u24 v9, 9, v12
    v_sub_u32 v9, v1, v9
    v_mul_u32_u24 v12, 9216, v12
    v_lshl_add_u32 v12, v9, 7, v12
    v_lshlrev_b32 v9, 7, v1
    s_sub_u32 s51, s31, 18
    s_mul_i32 s52, s51, 64512
    s_mul_i32 s53, s30, 1152
    s_add_u32 s52, s52, s53
    s_add_u32 s52, s52, 1179648
    s_mov_b32 exec_hi, 0x7fffffff
    s_mov_b64 exec, -1
    v_and_b32 v10, 0, v1
    v_lshlrev_b32 v10, 2, v10
L_fl_71:
    ds_read_b32 v11, v10 offset:2884
    s_waitcnt lgkmcnt(0)
    v_cmp_eq_u32 vcc, 0, v11
    s_cbranch_vccz L_fld_72
    s_sleep 1
    s_sub_u32 s60, s60, 1
    s_cmp_lg_u32 s60, 0
    s_cbranch_scc1 L_fl_71
    s_branch L_exit
L_fld_72:
    s_mov_b32 exec_hi, 0x7fffffff
    buffer_load_dword v16, v12, s[36:39], s52 offen
    buffer_load_dword v17, v12, s[40:43], s52 offen
    s_add_u32 s52, s52, 903168
    buffer_load_dword v18, v12, s[36:39], s52 offen
    buffer_load_dword v19, v12, s[40:43], s52 offen
    s_add_u32 s52, s52, 903168
    buffer_load_dword v20, v12, s[36:39], s52 offen
    buffer_load_dword v21, v12, s[40:43], s52 offen
    s_add_u32 s52, s52, 903168
    buffer_load_dword v22, v12, s[36:39], s52 offen
    buffer_load_dword v23, v12, s[40:43], s52 offen
    s_add_u32 s52, s52, 903168
    buffer_load_dword v24, v12, s[36:39], s52 offen
    buffer_load_dword v25, v12, s[40:43], s52 offen
    s_add_u32 s52, s52, 903168
    s_mov_b64 exec, -1
    s_lshl_b32 s54, s51, 13
    s_mul_i32 s53, s30, 663552
    s_add_u32 s54, s54, s53
    buffer_load_dword v26, v9, s[44:47], s54 offen
    s_add_u32 s54, s54, 114688
    buffer_load_dword v27, v9, s[44:47], s54 offen
    s_add_u32 s54, s54, 114688
    buffer_load_dword v28, v9, s[44:47], s54 offen
    s_add_u32 s54, s54, 114688
    buffer_load_dword v29, v9, s[44:47], s54 offen
    s_add_u32 s54, s54, 114688
    buffer_load_dword v30, v9, s[44:47], s54 offen
    s_add_u32 s54, s54, 114688
    s_cmp_ge_u32 s51, 11
    s_cbranch_scc1 L_help_e
    buffer_load_dword v31, v9, s[44:47], s54 offen
    s_add_u32 s54, s54, 114688
L_help_e:
L_exit:
L_end:
    s_endpgm
.section .rodata,"a"
.p2align 6
.amdhsa_kernel sequential_preLN__sliding_block_cached__moe_arch_mod__decode_kernel
  .amdhsa_next_free_vgpr 128
  .amdhsa_next_free_sgpr 100
  .amdhsa_accum_offset 128
  .amdhsa_group_segment_fixed_size 0
  .amdhsa_kernarg_size 104
  .amdhsa_user_sgpr_count 2
  .amdhsa_user_sgpr_kernarg_segment_ptr 1
  .amdhsa_system_sgpr_workgroup_id_x 1
  .amdhsa_float_denorm_mode_32 3
.end_amdhsa_kernel
```
